```python
import torch

def _softmax(x, axis=-1):
    return torch.softmax(x, dim=axis)

def _gelu(x):
    return torch.nn.functional.gelu(x, approximate='tanh')

def _silu(x):
    return torch.nn.functional.silu(x)

def _sigmoid(x):
    return torch.sigmoid(x)

def _layernorm(x, axis=-1, eps=1e-05):
    m = x.mean(dim=axis, keepdim=True)
    v = x.var(dim=axis, keepdim=True, unbiased=False)
    return (x - m) / torch.sqrt(v + eps)

def _scatter_add(tgt, idx, src, axis=0):
    return tgt.clone().index_add_(axis, idx, src)

def _segment_sum(src, seg, n):
    out = torch.zeros((n,) + src.shape[1:], dtype=src.dtype)
    return out.index_add_(0, seg, src)

def _pad(x, pw):
    flat = tuple((v for pair in reversed(pw) for v in pair))
    return torch.nn.functional.pad(x, flat)
kernel_name = 'standalone__factorization_afm__recsys'

def setup_inputs():

    _w = lambda a: (lambda t: t.to(torch.bfloat16) if t.is_floating_point() else t)(torch.as_tensor(a))
    B, F, D, V = (4096, 26, 128, min(1000, 100000))
    A = D
    ii, jj = tuple(torch.triu_indices(F, F, 1).unbind(0))
    return {'idx': _w((lambda lo, hi, *s: torch.randint(lo, hi, s))(0, V, B, F).to(torch.int64)), 'table': _w((lambda *s: torch.randn(*s, dtype=torch.bfloat16) * 0.2)(V, D)), 'ii': _w(ii.to(torch.int64)), 'jj': _w(jj.to(torch.int64)), 'W': _w((lambda *s: torch.randn(*s, dtype=torch.bfloat16) * 1.6)(D, A) * (1.0 / D ** 0.5)), 'b': _w((lambda *s: torch.randn(*s, dtype=torch.bfloat16) * 1.6)(A)), 'h': _w((lambda *s: torch.randn(*s, dtype=torch.bfloat16) * 1.6)(A)), 'p': _w((lambda *s: torch.randn(*s, dtype=torch.bfloat16) * 0.2)(D))}

def reference(idx, table, ii, jj, W, b, h, p):
    emb = table[idx]
    ei = emb[:, ii, :].clone()
    ej = emb[:, jj, :].clone()
    pair = ei * ej
    hid = pair @ W + b
    hid = 0.5 * (hid + torch.abs(hid))
    e = hid @ h
    alpha = _softmax(e, axis=-1)
    pooled = torch.einsum('bp,bpd->bd', alpha, pair)
    return pooled @ p
```

```asm
; @launch grid=(256,1,1) block=(512,1,1) lds=163840
.amdgcn_target "amdgcn-amd-amdhsa--gfx950"
.text
.globl standalone__factorization_afm__recsys_kernel
.p2align 8
.type standalone__factorization_afm__recsys_kernel,@function
standalone__factorization_afm__recsys_kernel:
  s_cmp_ge_u32 s2, 256
  s_cbranch_scc1 L_end
  s_load_dwordx16 s[4:19], s[0:1], 0
  s_load_dwordx4 s[20:23], s[0:1], 64
  s_load_dwordx2 s[24:25], s[0:1], 80
  v_lshrrev_b32 v221, 6, v0
  v_and_b32 v223, 63, v0
  s_nop 0
  v_readfirstlane_b32 s3, v221
  v_mov_b32 v221, v223
  s_nop 2
  s_and_b32 s26, s3, 3
  s_lshl_b32 s27, s2, 2
  s_add_u32 s27, s27, s26
  s_cmp_ge_u32 s3, 4
  s_cbranch_scc1 L_help
L_mfma:
  s_cmp_ge_u32 s2, 250
  s_cbranch_scc1 L_end
  v_lshrrev_b32 v222, 4, v221
  v_and_b32 v223, 15, v221
  v_lshlrev_b32 v207, 2, v222
  v_xor_b32 v207, v207, v223
  v_lshlrev_b32 v206, 8, v222
  v_lshl_add_u32 v202, v207, 4, v206
  v_xor_b32 v203, 16, v202
  v_xor_b32 v204, 32, v202
  v_xor_b32 v205, 48, v202
  s_lshl_b32 s52, s26, 13
  s_add_u32 s53, s52, 131072
  s_mov_b32 m0, s53
  s_waitcnt lgkmcnt(0)
  s_mov_b32 s32, s12
  s_mov_b32 s33, s13
  s_mov_b32 s34, 32768
  s_mov_b32 s35, 0x20000
  buffer_load_dwordx4 v202, s[32:35], s52 offen offset:0 lds
  buffer_load_dwordx4 v203, s[32:35], s52 offen offset:1024 lds
  buffer_load_dwordx4 v204, s[32:35], s52 offen offset:2048 lds
  buffer_load_dwordx4 v205, s[32:35], s52 offen offset:3072 lds
  s_add_u32 s52, s52, 4096
  s_add_u32 m0, m0, 4096
  s_nop 0
  buffer_load_dwordx4 v202, s[32:35], s52 offen offset:0 lds
  buffer_load_dwordx4 v203, s[32:35], s52 offen offset:1024 lds
  buffer_load_dwordx4 v204, s[32:35], s52 offen offset:2048 lds
  buffer_load_dwordx4 v205, s[32:35], s52 offen offset:3072 lds
  s_setprio 1
  v_lshrrev_b32 v209, 2, v223
  s_mov_b32 s28, s6
  s_mov_b32 s29, s7
  s_mov_b32 s30, 256000
  s_mov_b32 s31, 0x20000
  v_lshlrev_b32 v210, 4, v209
  s_lshl_b32 s54, s27, 8
  buffer_load_dwordx4 v[184:187], v210, s[28:31], s54 offen offset:0
  buffer_load_dwordx4 v[188:191], v210, s[28:31], s54 offen offset:64
  buffer_load_dwordx4 v[192:195], v210, s[28:31], s54 offen offset:128
  buffer_load_dwordx4 v[196:199], v210, s[28:31], s54 offen offset:192
  s_barrier
  v_cmp_eq_u32 vcc, v222, v209
  v_and_b32 v208, 1, v221
  v_cmp_eq_u32 s[56:57], 1, v208
  v_mov_b32 v207, 0xffff
  v_mov_b32 v206, 0xffff0000
  v_cndmask_b32 v208, v207, v206, s[56:57]
  v_cndmask_b32 v208, 0, v208, vcc
  v_and_b32 v207, 2, v221
  v_cmp_eq_u32 vcc, 0, v207
  s_nop 1
  v_cndmask_b32 v200, 0, v208, vcc
  v_cndmask_b32 v201, v208, 0, vcc
  v_bfe_u32 v206, v221, 2, 2
  v_lshlrev_b32 v207, 3, v222
  v_add_u32 v207, v207, v206
  v_lshlrev_b32 v207, 8, v207
  v_and_b32 v208, 1, v221
  v_lshl_add_u32 v207, v208, 3, v207
  v_add_u32 v207, 131072, v207
  v_bfe_u32 v208, v221, 1, 1
  v_lshlrev_b32 v206, 2, v206
  v_lshlrev_b32 v209, 1, v222
  v_and_b32 v209, 3, v209
  v_or_b32 v209, v209, v206
  v_xor_b32 v209, v209, v208
  v_lshl_add_u32 v168, v209, 4, v207
  v_xor_b32 v169, 32, v168
  v_xor_b32 v170, 64, v168
  v_xor_b32 v171, 96, v168
  v_xor_b32 v172, 128, v168
  v_xor_b32 v173, 160, v168
  v_xor_b32 v174, 192, v168
  v_xor_b32 v175, 224, v168
  v_lshlrev_b32 v209, 1, v222
  v_add_u32 v209, 1, v209
  v_and_b32 v209, 3, v209
  v_or_b32 v209, v209, v206
  v_xor_b32 v209, v209, v208
  v_lshl_add_u32 v176, v209, 4, v207
  v_xor_b32 v177, 32, v176
  v_xor_b32 v178, 64, v176
  v_xor_b32 v179, 96, v176
  v_xor_b32 v180, 128, v176
  v_xor_b32 v181, 160, v176
  v_xor_b32 v182, 192, v176
  v_xor_b32 v183, 224, v176
  v_lshlrev_b32 v207, 8, v223
  v_or_b32 v206, 0, v222
  v_xor_b32 v206, v206, v223
  v_lshl_add_u32 v214, v206, 4, v207
  v_or_b32 v206, 4, v222
  v_xor_b32 v206, v206, v223
  v_lshl_add_u32 v215, v206, 4, v207
  v_or_b32 v206, 8, v222
  v_xor_b32 v206, v206, v223
  v_lshl_add_u32 v216, v206, 4, v207
  v_or_b32 v206, 12, v222
  v_xor_b32 v206, v206, v223
  v_lshl_add_u32 v217, v206, 4, v207
  s_lshl_b32 s52, s26, 8
  s_add_u32 s52, s52, 146432
  v_lshlrev_b32 v218, 2, v221
  v_add_u32 v218, s52, v218
  s_lshl_b32 s52, s26, 2
  s_add_u32 s52, s52, 130560
  v_and_b32 v206, 31, v221
  v_lshlrev_b32 v206, 2, v206
  v_add_u32 v206, 130928, v206
  v_cmp_eq_u32 vcc, 0, v221
  v_mov_b32 v219, s52
  s_nop 0
  v_cndmask_b32 v219, v206, v219, vcc
  v_mov_b32 v220, -1
  v_lshlrev_b32 v202, 4, v222
  v_add_u32 v202, 129024, v202
  v_mov_b32 v203, 130560
  v_mov_b32 v204, 1
  v_mov_b32 v130, 0
  v_mov_b32 v131, 0
  v_mov_b32 v136, 0
  v_mov_b32 v137, 0
  v_mov_b32 v142, 0
  v_mov_b32 v143, 0
  v_mov_b32 v148, 0
  v_mov_b32 v149, 0
  v_mov_b32 v221, 130608
  s_waitcnt vmcnt(0)
  s_mov_b64 exec, 1
  ds_add_u32 v203, v204 offset:40
  s_mov_b64 exec, -1
  s_mov_b32 s79, 0
L_spinWL_1:
  ds_read_b32 v206, v203 offset:40
  s_waitcnt lgkmcnt(0)
  v_readfirstlane_b32 s60, v206
  s_add_u32 s79, s79, 1
  s_cmp_ge_u32 s60, 4
  s_cbranch_scc1 L_spinxWL_2
  s_cmp_gt_u32 s79, 0x100000
  s_cbranch_scc1 L_spinxWL_2
  s_sleep 0
  s_branch L_spinWL_1
L_spinxWL_2:
  ds_read_b64_tr_b16 a[0:1], v168 offset:0
  ds_read_b64_tr_b16 a[2:3], v176 offset:1024
  ds_read_b64_tr_b16 a[4:5], v169 offset:0
  ds_read_b64_tr_b16 a[6:7], v177 offset:1024
  ds_read_b64_tr_b16 a[8:9], v170 offset:0
  ds_read_b64_tr_b16 a[10:11], v178 offset:1024
  ds_read_b64_tr_b16 a[12:13], v171 offset:0
  ds_read_b64_tr_b16 a[14:15], v179 offset:1024
  ds_read_b64_tr_b16 a[16:17], v172 offset:0
  ds_read_b64_tr_b16 a[18:19], v180 offset:1024
  s_waitcnt lgkmcnt(10)
  v_and_b32 v128, v184, v200
  v_and_b32 v129, v185, v201
  v_and_b32 v132, v186, v200
  v_and_b32 v133, v187, v201
  v_and_b32 v134, v188, v200
  v_and_b32 v135, v189, v201
  v_and_b32 v138, v190, v200
  v_and_b32 v139, v191, v201
  v_and_b32 v140, v192, v200
  v_and_b32 v141, v193, v201
  v_and_b32 v144, v194, v200
  v_and_b32 v145, v195, v201
  v_and_b32 v146, v196, v200
  v_and_b32 v147, v197, v201
  v_and_b32 v150, v198, v200
  v_and_b32 v151, v199, v201
  ds_read_b64_tr_b16 a[20:21], v173 offset:0
  ds_read_b64_tr_b16 a[22:23], v181 offset:1024
  s_waitcnt lgkmcnt(8)
  v_mfma_f32_16x16x32_bf16 v[152:155], v[128:131], a[0:3], 0
  ds_read_b64_tr_b16 a[24:25], v174 offset:0
  v_mfma_f32_16x16x32_bf16 v[156:159], v[130:133], a[0:3], 0
  ds_read_b64_tr_b16 a[26:27], v182 offset:1024
  v_mfma_f32_16x16x32_bf16 v[160:163], v[128:131], a[4:7], 0
  ds_read_b64_tr_b16 a[28:29], v175 offset:0
  s_nop 3
  v_cvt_pk_bf16_f32 v0, v152, v153
  v_cvt_pk_bf16_f32 v1, v154, v155
  v_mfma_f32_16x16x32_bf16 v[164:167], v[130:133], a[4:7], 0
  ds_read_b64_tr_b16 a[30:31], v183 offset:1024
  s_nop 1
  v_cvt_pk_bf16_f32 v2, v156, v157
  v_cvt_pk_bf16_f32 v3, v158, v159
  s_waitcnt lgkmcnt(8)
  v_mfma_f32_16x16x32_bf16 v[152:155], v[128:131], a[8:11], 0
  ds_read_b64_tr_b16 a[0:1], v168 offset:8192
  v_cvt_pk_bf16_f32 v16, v160, v161
  v_cvt_pk_bf16_f32 v17, v162, v163
  v_mfma_f32_16x16x32_bf16 v[156:159], v[130:133], a[8:11], 0
  ds_read_b64_tr_b16 a[2:3], v176 offset:9216
  v_cvt_pk_bf16_f32 v18, v164, v165
  v_cvt_pk_bf16_f32 v19, v166, v167
  v_mfma_f32_16x16x32_bf16 v[160:163], v[128:131], a[12:15], 0
  ds_read_b64_tr_b16 a[4:5], v169 offset:8192
  v_cvt_pk_bf16_f32 v32, v152, v153
  v_cvt_pk_bf16_f32 v33, v154, v155
  v_mfma_f32_16x16x32_bf16 v[164:167], v[130:133], a[12:15], 0
  ds_read_b64_tr_b16 a[6:7], v177 offset:9216
  v_cvt_pk_bf16_f32 v34, v156, v157
  v_cvt_pk_bf16_f32 v35, v158, v159
  s_waitcnt lgkmcnt(8)
  v_mfma_f32_16x16x32_bf16 v[152:155], v[128:131], a[16:19], 0
  ds_read_b64_tr_b16 a[8:9], v170 offset:8192
  v_cvt_pk_bf16_f32 v48, v160, v161
  v_cvt_pk_bf16_f32 v49, v162, v163
  v_mfma_f32_16x16x32_bf16 v[156:159], v[130:133], a[16:19], 0
  ds_read_b64_tr_b16 a[10:11], v178 offset:9216
  v_cvt_pk_bf16_f32 v50, v164, v165
  v_cvt_pk_bf16_f32 v51, v166, v167
  v_mfma_f32_16x16x32_bf16 v[160:163], v[128:131], a[20:23], 0
  ds_read_b64_tr_b16 a[12:13], v171 offset:8192
  v_cvt_pk_bf16_f32 v64, v152, v153
  v_cvt_pk_bf16_f32 v65, v154, v155
  v_mfma_f32_16x16x32_bf16 v[164:167], v[130:133], a[20:23], 0
  ds_read_b64_tr_b16 a[14:15], v179 offset:9216
  v_cvt_pk_bf16_f32 v66, v156, v157
  v_cvt_pk_bf16_f32 v67, v158, v159
  s_waitcnt lgkmcnt(8)
  v_mfma_f32_16x16x32_bf16 v[152:155], v[128:131], a[24:27], 0
  ds_read_b64_tr_b16 a[16:17], v172 offset:8192
  v_cvt_pk_bf16_f32 v80, v160, v161
  v_cvt_pk_bf16_f32 v81, v162, v163
  v_mfma_f32_16x16x32_bf16 v[156:159], v[130:133], a[24:27], 0
  ds_read_b64_tr_b16 a[18:19], v180 offset:9216
  v_cvt_pk_bf16_f32 v82, v164, v165
  v_cvt_pk_bf16_f32 v83, v166, v167
  v_mfma_f32_16x16x32_bf16 v[160:163], v[128:131], a[28:31], 0
  ds_read_b64_tr_b16 a[20:21], v173 offset:8192
  v_cvt_pk_bf16_f32 v96, v152, v153
  v_cvt_pk_bf16_f32 v97, v154, v155
  v_mfma_f32_16x16x32_bf16 v[164:167], v[130:133], a[28:31], 0
  ds_read_b64_tr_b16 a[22:23], v181 offset:9216
  v_cvt_pk_bf16_f32 v98, v156, v157
  v_cvt_pk_bf16_f32 v99, v158, v159
  s_waitcnt lgkmcnt(8)
  v_mfma_f32_16x16x32_bf16 v[152:155], v[134:137], a[0:3], 0
  ds_read_b64_tr_b16 a[24:25], v174 offset:8192
  v_cvt_pk_bf16_f32 v112, v160, v161
  v_cvt_pk_bf16_f32 v113, v162, v163
  v_mfma_f32_16x16x32_bf16 v[156:159], v[136:139], a[0:3], 0
  ds_read_b64_tr_b16 a[26:27], v182 offset:9216
  v_cvt_pk_bf16_f32 v114, v164, v165
  v_cvt_pk_bf16_f32 v115, v166, v167
  v_mfma_f32_16x16x32_bf16 v[160:163], v[134:137], a[4:7], 0
  ds_read_b64_tr_b16 a[28:29], v175 offset:8192
  v_cvt_pk_bf16_f32 v4, v152, v153
  v_cvt_pk_bf16_f32 v5, v154, v155
  v_mfma_f32_16x16x32_bf16 v[164:167], v[136:139], a[4:7], 0
  ds_read_b64_tr_b16 a[30:31], v183 offset:9216
  v_cvt_pk_bf16_f32 v6, v156, v157
  v_cvt_pk_bf16_f32 v7, v158, v159
  s_waitcnt lgkmcnt(8)
  v_mfma_f32_16x16x32_bf16 v[152:155], v[134:137], a[8:11], 0
  ds_read_b64_tr_b16 a[0:1], v168 offset:16384
  v_cvt_pk_bf16_f32 v20, v160, v161
  v_cvt_pk_bf16_f32 v21, v162, v163
  v_mfma_f32_16x16x32_bf16 v[156:159], v[136:139], a[8:11], 0
  ds_read_b64_tr_b16 a[2:3], v176 offset:17408
  v_cvt_pk_bf16_f32 v22, v164, v165
  v_cvt_pk_bf16_f32 v23, v166, v167
  v_mfma_f32_16x16x32_bf16 v[160:163], v[134:137], a[12:15], 0
  ds_read_b64_tr_b16 a[4:5], v169 offset:16384
  v_cvt_pk_bf16_f32 v36, v152, v153
  v_cvt_pk_bf16_f32 v37, v154, v155
  v_mfma_f32_16x16x32_bf16 v[164:167], v[136:139], a[12:15], 0
  ds_read_b64_tr_b16 a[6:7], v177 offset:17408
  v_cvt_pk_bf16_f32 v38, v156, v157
  v_cvt_pk_bf16_f32 v39, v158, v159
  s_waitcnt lgkmcnt(8)
  v_mfma_f32_16x16x32_bf16 v[152:155], v[134:137], a[16:19], 0
  ds_read_b64_tr_b16 a[8:9], v170 offset:16384
  v_cvt_pk_bf16_f32 v52, v160, v161
  v_cvt_pk_bf16_f32 v53, v162, v163
  v_mfma_f32_16x16x32_bf16 v[156:159], v[136:139], a[16:19], 0
  ds_read_b64_tr_b16 a[10:11], v178 offset:17408
  v_cvt_pk_bf16_f32 v54, v164, v165
  v_cvt_pk_bf16_f32 v55, v166, v167
  v_mfma_f32_16x16x32_bf16 v[160:163], v[134:137], a[20:23], 0
  ds_read_b64_tr_b16 a[12:13], v171 offset:16384
  v_cvt_pk_bf16_f32 v68, v152, v153
  v_cvt_pk_bf16_f32 v69, v154, v155
  v_mfma_f32_16x16x32_bf16 v[164:167], v[136:139], a[20:23], 0
  ds_read_b64_tr_b16 a[14:15], v179 offset:17408
  v_cvt_pk_bf16_f32 v70, v156, v157
  v_cvt_pk_bf16_f32 v71, v158, v159
  s_waitcnt lgkmcnt(8)
  v_mfma_f32_16x16x32_bf16 v[152:155], v[134:137], a[24:27], 0
  ds_read_b64_tr_b16 a[16:17], v172 offset:16384
  v_cvt_pk_bf16_f32 v84, v160, v161
  v_cvt_pk_bf16_f32 v85, v162, v163
  v_mfma_f32_16x16x32_bf16 v[156:159], v[136:139], a[24:27], 0
  ds_read_b64_tr_b16 a[18:19], v180 offset:17408
  v_cvt_pk_bf16_f32 v86, v164, v165
  v_cvt_pk_bf16_f32 v87, v166, v167
  v_mfma_f32_16x16x32_bf16 v[160:163], v[134:137], a[28:31], 0
  ds_read_b64_tr_b16 a[20:21], v173 offset:16384
  v_cvt_pk_bf16_f32 v100, v152, v153
  v_cvt_pk_bf16_f32 v101, v154, v155
  v_mfma_f32_16x16x32_bf16 v[164:167], v[136:139], a[28:31], 0
  ds_read_b64_tr_b16 a[22:23], v181 offset:17408
  v_cvt_pk_bf16_f32 v102, v156, v157
  v_cvt_pk_bf16_f32 v103, v158, v159
  s_waitcnt lgkmcnt(8)
  v_mfma_f32_16x16x32_bf16 v[152:155], v[140:143], a[0:3], 0
  ds_read_b64_tr_b16 a[24:25], v174 offset:16384
  v_cvt_pk_bf16_f32 v116, v160, v161
  v_cvt_pk_bf16_f32 v117, v162, v163
  v_mfma_f32_16x16x32_bf16 v[156:159], v[142:145], a[0:3], 0
  ds_read_b64_tr_b16 a[26:27], v182 offset:17408
  v_cvt_pk_bf16_f32 v118, v164, v165
  v_cvt_pk_bf16_f32 v119, v166, v167
  v_mfma_f32_16x16x32_bf16 v[160:163], v[140:143], a[4:7], 0
  ds_read_b64_tr_b16 a[28:29], v175 offset:16384
  v_cvt_pk_bf16_f32 v8, v152, v153
  v_cvt_pk_bf16_f32 v9, v154, v155
  v_mfma_f32_16x16x32_bf16 v[164:167], v[142:145], a[4:7], 0
  ds_read_b64_tr_b16 a[30:31], v183 offset:17408
  v_cvt_pk_bf16_f32 v10, v156, v157
  v_cvt_pk_bf16_f32 v11, v158, v159
  s_waitcnt lgkmcnt(8)
  v_mfma_f32_16x16x32_bf16 v[152:155], v[140:143], a[8:11], 0
  ds_read_b64_tr_b16 a[0:1], v168 offset:24576
  v_cvt_pk_bf16_f32 v24, v160, v161
  v_cvt_pk_bf16_f32 v25, v162, v163
  v_mfma_f32_16x16x32_bf16 v[156:159], v[142:145], a[8:11], 0
  ds_read_b64_tr_b16 a[2:3], v176 offset:25600
  v_cvt_pk_bf16_f32 v26, v164, v165
  v_cvt_pk_bf16_f32 v27, v166, v167
  v_mfma_f32_16x16x32_bf16 v[160:163], v[140:143], a[12:15], 0
  ds_read_b64_tr_b16 a[4:5], v169 offset:24576
  v_cvt_pk_bf16_f32 v40, v152, v153
  v_cvt_pk_bf16_f32 v41, v154, v155
  v_mfma_f32_16x16x32_bf16 v[164:167], v[142:145], a[12:15], 0
  ds_read_b64_tr_b16 a[6:7], v177 offset:25600
  v_cvt_pk_bf16_f32 v42, v156, v157
  v_cvt_pk_bf16_f32 v43, v158, v159
  s_waitcnt lgkmcnt(8)
  v_mfma_f32_16x16x32_bf16 v[152:155], v[140:143], a[16:19], 0
  ds_read_b64_tr_b16 a[8:9], v170 offset:24576
  v_cvt_pk_bf16_f32 v56, v160, v161
  v_cvt_pk_bf16_f32 v57, v162, v163
  v_mfma_f32_16x16x32_bf16 v[156:159], v[142:145], a[16:19], 0
  ds_read_b64_tr_b16 a[10:11], v178 offset:25600
  v_cvt_pk_bf16_f32 v58, v164, v165
  v_cvt_pk_bf16_f32 v59, v166, v167
  v_mfma_f32_16x16x32_bf16 v[160:163], v[140:143], a[20:23], 0
  ds_read_b64_tr_b16 a[12:13], v171 offset:24576
  v_cvt_pk_bf16_f32 v72, v152, v153
  v_cvt_pk_bf16_f32 v73, v154, v155
  v_mfma_f32_16x16x32_bf16 v[164:167], v[142:145], a[20:23], 0
  ds_read_b64_tr_b16 a[14:15], v179 offset:25600
  v_cvt_pk_bf16_f32 v74, v156, v157
  v_cvt_pk_bf16_f32 v75, v158, v159
  s_waitcnt lgkmcnt(8)
  v_mfma_f32_16x16x32_bf16 v[152:155], v[140:143], a[24:27], 0
  ds_read_b64_tr_b16 a[16:17], v172 offset:24576
  v_cvt_pk_bf16_f32 v88, v160, v161
  v_cvt_pk_bf16_f32 v89, v162, v163
  v_mfma_f32_16x16x32_bf16 v[156:159], v[142:145], a[24:27], 0
  ds_read_b64_tr_b16 a[18:19], v180 offset:25600
  v_cvt_pk_bf16_f32 v90, v164, v165
  v_cvt_pk_bf16_f32 v91, v166, v167
  v_mfma_f32_16x16x32_bf16 v[160:163], v[140:143], a[28:31], 0
  ds_read_b64_tr_b16 a[20:21], v173 offset:24576
  v_cvt_pk_bf16_f32 v104, v152, v153
  v_cvt_pk_bf16_f32 v105, v154, v155
  v_mfma_f32_16x16x32_bf16 v[164:167], v[142:145], a[28:31], 0
  ds_read_b64_tr_b16 a[22:23], v181 offset:25600
  v_cvt_pk_bf16_f32 v106, v156, v157
  v_cvt_pk_bf16_f32 v107, v158, v159
  s_waitcnt lgkmcnt(8)
  v_mfma_f32_16x16x32_bf16 v[152:155], v[146:149], a[0:3], 0
  ds_read_b64_tr_b16 a[24:25], v174 offset:24576
  v_cvt_pk_bf16_f32 v120, v160, v161
  v_cvt_pk_bf16_f32 v121, v162, v163
  v_mfma_f32_16x16x32_bf16 v[156:159], v[148:151], a[0:3], 0
  ds_read_b64_tr_b16 a[26:27], v182 offset:25600
  v_cvt_pk_bf16_f32 v122, v164, v165
  v_cvt_pk_bf16_f32 v123, v166, v167
  v_mfma_f32_16x16x32_bf16 v[160:163], v[146:149], a[4:7], 0
  ds_read_b64_tr_b16 a[28:29], v175 offset:24576
  v_cvt_pk_bf16_f32 v12, v152, v153
  v_cvt_pk_bf16_f32 v13, v154, v155
  v_mfma_f32_16x16x32_bf16 v[164:167], v[148:151], a[4:7], 0
  ds_read_b64_tr_b16 a[30:31], v183 offset:25600
  v_cvt_pk_bf16_f32 v14, v156, v157
  v_cvt_pk_bf16_f32 v15, v158, v159
  s_waitcnt lgkmcnt(8)
  v_mfma_f32_16x16x32_bf16 v[152:155], v[146:149], a[8:11], 0
  s_nop 0
  v_cvt_pk_bf16_f32 v28, v160, v161
  v_cvt_pk_bf16_f32 v29, v162, v163
  v_mfma_f32_16x16x32_bf16 v[156:159], v[148:151], a[8:11], 0
  s_nop 0
  v_cvt_pk_bf16_f32 v30, v164, v165
  v_cvt_pk_bf16_f32 v31, v166, v167
  v_mfma_f32_16x16x32_bf16 v[160:163], v[146:149], a[12:15], 0
  s_nop 0
  v_cvt_pk_bf16_f32 v44, v152, v153
  v_cvt_pk_bf16_f32 v45, v154, v155
  v_mfma_f32_16x16x32_bf16 v[164:167], v[148:151], a[12:15], 0
  s_nop 0
  v_cvt_pk_bf16_f32 v46, v156, v157
  v_cvt_pk_bf16_f32 v47, v158, v159
  s_waitcnt lgkmcnt(4)
  v_mfma_f32_16x16x32_bf16 v[152:155], v[146:149], a[16:19], 0
  s_nop 0
  v_cvt_pk_bf16_f32 v60, v160, v161
  v_cvt_pk_bf16_f32 v61, v162, v163
  v_mfma_f32_16x16x32_bf16 v[156:159], v[148:151], a[16:19], 0
  s_nop 0
  v_cvt_pk_bf16_f32 v62, v164, v165
  v_cvt_pk_bf16_f32 v63, v166, v167
  v_mfma_f32_16x16x32_bf16 v[160:163], v[146:149], a[20:23], 0
  s_nop 0
  v_cvt_pk_bf16_f32 v76, v152, v153
  v_cvt_pk_bf16_f32 v77, v154, v155
  v_mfma_f32_16x16x32_bf16 v[164:167], v[148:151], a[20:23], 0
  s_nop 0
  v_cvt_pk_bf16_f32 v78, v156, v157
  v_cvt_pk_bf16_f32 v79, v158, v159
  s_waitcnt lgkmcnt(0)
  v_mfma_f32_16x16x32_bf16 v[152:155], v[146:149], a[24:27], 0
  s_nop 0
  v_cvt_pk_bf16_f32 v92, v160, v161
  v_cvt_pk_bf16_f32 v93, v162, v163
  v_mfma_f32_16x16x32_bf16 v[156:159], v[148:151], a[24:27], 0
  s_nop 0
  v_cvt_pk_bf16_f32 v94, v164, v165
  v_cvt_pk_bf16_f32 v95, v166, v167
  v_mfma_f32_16x16x32_bf16 v[160:163], v[146:149], a[28:31], 0
  s_nop 0
  v_cvt_pk_bf16_f32 v108, v152, v153
  v_cvt_pk_bf16_f32 v109, v154, v155
  v_mfma_f32_16x16x32_bf16 v[164:167], v[148:151], a[28:31], 0
  s_nop 0
  v_cvt_pk_bf16_f32 v110, v156, v157
  v_cvt_pk_bf16_f32 v111, v158, v159
  s_mov_b64 exec, 1
  ds_add_u32 v203, v204 offset:28
  s_mov_b64 exec, -1
  s_nop 4
  v_cvt_pk_bf16_f32 v124, v160, v161
  v_cvt_pk_bf16_f32 v125, v162, v163
  v_cvt_pk_bf16_f32 v126, v164, v165
  v_cvt_pk_bf16_f32 v127, v166, v167
  s_mov_b32 s79, 0
L_spinR_3:
  ds_read_b32 v206, v203 offset:24
  s_waitcnt lgkmcnt(0)
  v_readfirstlane_b32 s60, v206
  s_add_u32 s79, s79, 1
  s_cmp_ge_u32 s60, 5
  s_cbranch_scc1 L_spinxR_4
  s_cmp_gt_u32 s79, 0x100000
  s_cbranch_scc1 L_spinxR_4
  s_sleep 1
  s_branch L_spinR_3
L_spinxR_4:
  ds_read_b128 a[0:3], v214
  ds_read_b128 a[4:7], v215
  ds_read_b128 a[8:11], v216
  ds_read_b128 a[12:15], v217
  ds_read_b128 v[128:131], v202 offset:0
  ds_read_b128 v[132:135], v202 offset:64
  ds_read_b128 v[136:139], v202 offset:128
  ds_read_b128 v[140:143], v202 offset:192
  ds_read_b128 v[144:147], v202 offset:256
  ds_read_b128 v[148:151], v202 offset:320
  ds_read_b128 v[152:155], v202 offset:384
  ds_read_b128 v[156:159], v202 offset:448
  s_waitcnt lgkmcnt(6)
  ds_read_b128 v[160:163], v202 offset:512
  ds_read_b128 v[164:167], v202 offset:576
  ds_read_b128 v[168:171], v202 offset:640
  ds_read_b128 v[172:175], v202 offset:704
  ds_read_b128 v[176:179], v202 offset:768
  ds_read_b128 v[180:183], v202 offset:832
  ds_read_b128 v[184:187], v202 offset:896
  ds_read_b128 v[188:191], v202 offset:960
  s_mov_b32 s61, 0
  s_movk_i32 s62, 0x09
  .p2align 6
L_mloop:
  s_waitcnt lgkmcnt(0)
  v_mfma_f32_16x16x32_bf16 v[192:195], v[0:3], a[0:3], v[128:131]
  v_fma_f32 v211, |v200|, v184, v211
  v_mfma_f32_16x16x32_bf16 v[192:195], v[4:7], a[4:7], v[192:195]
  ds_read_b32 v222, v221 offset:8
  v_mfma_f32_16x16x32_bf16 v[192:195], v[8:11], a[8:11], v[192:195]
  v_fma_f32 v211, |v201|, v185, v211
  v_fma_f32 v211, |v202|, v186, v211
  v_mfma_f32_16x16x32_bf16 v[192:195], v[12:15], a[12:15], v[192:195]
  v_fma_f32 v211, |v203|, v187, v211
  v_mfma_f32_16x16x32_bf16 v[196:199], v[28:31], a[12:15], v[132:135]
  v_fma_f32 v211, |v204|, v188, v211
  v_fma_f32 v211, |v205|, v189, v211
  v_mfma_f32_16x16x32_bf16 v[196:199], v[24:27], a[8:11], v[196:199]
  ds_read_b128 a[16:19], v214 offset:4096
  v_mfma_f32_16x16x32_bf16 v[196:199], v[20:23], a[4:7], v[196:199]
  v_fma_f32 v211, |v206|, v190, v211
  v_mfma_f32_16x16x32_bf16 v[196:199], v[16:19], a[0:3], v[196:199]
  v_fma_f32 v211, |v207|, v191, v211
  v_mfma_f32_16x16x32_bf16 v[200:203], v[32:35], a[0:3], v[136:139]
  v_mul_f32_e64 v208, |v192|, v160
  v_fma_f32 v208, |v193|, v161, v208
  v_mfma_f32_16x16x32_bf16 v[200:203], v[36:39], a[4:7], v[200:203]
  ds_read_b128 a[20:23], v215 offset:4096
  v_mfma_f32_16x16x32_bf16 v[200:203], v[40:43], a[8:11], v[200:203]
  v_fma_f32 v208, |v194|, v162, v208
  v_permlane32_swap_b32 v209, v211
  v_mfma_f32_16x16x32_bf16 v[200:203], v[44:47], a[12:15], v[200:203]
  v_fma_f32 v208, |v195|, v163, v208
  v_mfma_f32_16x16x32_bf16 v[204:207], v[60:63], a[12:15], v[140:143]
  v_fma_f32 v208, |v196|, v164, v208
  v_fma_f32 v208, |v197|, v165, v208
  v_mfma_f32_16x16x32_bf16 v[204:207], v[56:59], a[8:11], v[204:207]
  ds_read_b128 a[24:27], v216 offset:4096
  v_mfma_f32_16x16x32_bf16 v[204:207], v[52:55], a[4:7], v[204:207]
  v_fma_f32 v208, |v198|, v166, v208
  v_add_f32 v213, v209, v211
  v_mfma_f32_16x16x32_bf16 v[204:207], v[48:51], a[0:3], v[204:207]
  v_fma_f32 v208, |v199|, v167, v208
  v_mfma_f32_16x16x32_bf16 v[192:195], v[64:67], a[0:3], v[144:147]
  v_fma_f32 v208, |v200|, v168, v208
  v_fma_f32 v208, |v201|, v169, v208
  v_mfma_f32_16x16x32_bf16 v[192:195], v[68:71], a[4:7], v[192:195]
  ds_read_b128 a[28:31], v217 offset:4096
  v_mfma_f32_16x16x32_bf16 v[192:195], v[72:75], a[8:11], v[192:195]
  v_fma_f32 v208, |v202|, v170, v208
  v_mfma_f32_16x16x32_bf16 v[192:195], v[76:79], a[12:15], v[192:195]
  v_fma_f32 v208, |v203|, v171, v208
  v_mfma_f32_16x16x32_bf16 v[196:199], v[92:95], a[12:15], v[148:151]
  v_fma_f32 v208, |v204|, v172, v208
  v_permlane16_swap_b32 v212, v213
  v_mfma_f32_16x16x32_bf16 v[196:199], v[88:91], a[8:11], v[196:199]
  v_fma_f32 v208, |v205|, v173, v208
  v_mfma_f32_16x16x32_bf16 v[196:199], v[84:87], a[4:7], v[196:199]
  v_fma_f32 v208, |v206|, v174, v208
  v_add_f32 v212, v212, v213
  v_mfma_f32_16x16x32_bf16 v[196:199], v[80:83], a[0:3], v[196:199]
  v_fma_f32 v208, |v207|, v175, v208
  v_add_u32 v220, 1, v220
  v_mfma_f32_16x16x32_bf16 v[200:203], v[96:99], a[0:3], v[152:155]
  v_fma_f32 v208, |v192|, v176, v208
  s_cmp_eq_u32 s61, 0
  s_cbranch_scc1 L_noE
  s_cmp_lg_u32 s61, 1
  s_cbranch_scc1 L_doE
  s_waitcnt lgkmcnt(4)
  v_readfirstlane_b32 s60, v222
  s_nop 3
  s_cmp_ge_u32 s60, 4
  s_cbranch_scc1 L_doE
  s_mov_b32 s79, 0
L_spinWH_5:
  ds_read_b32 v222, v221 offset:8
  s_waitcnt lgkmcnt(0)
  v_readfirstlane_b32 s60, v222
  s_add_u32 s79, s79, 1
  s_cmp_ge_u32 s60, 4
  s_cbranch_scc1 L_spinxWH_6
  s_cmp_gt_u32 s79, 0x100000
  s_cbranch_scc1 L_spinxWH_6
  s_sleep 1
  s_branch L_spinWH_5
L_spinxWH_6:
L_doE:
  ds_write_b32 v218, v212
  ds_write_b32 v219, v220
L_noE:
  v_mfma_f32_16x16x32_bf16 v[200:203], v[100:103], a[4:7], v[200:203]
  v_fma_f32 v208, |v193|, v177, v208
  v_mfma_f32_16x16x32_bf16 v[200:203], v[104:107], a[8:11], v[200:203]
  v_fma_f32 v208, |v194|, v178, v208
  v_add_u32 v218, 1024, v218
  v_mfma_f32_16x16x32_bf16 v[200:203], v[108:111], a[12:15], v[200:203]
  v_fma_f32 v208, |v195|, v179, v208
  v_mfma_f32_16x16x32_bf16 v[204:207], v[124:127], a[12:15], v[156:159]
  v_fma_f32 v208, |v196|, v180, v208
  v_mfma_f32_16x16x32_bf16 v[204:207], v[120:123], a[8:11], v[204:207]
  v_fma_f32 v208, |v197|, v181, v208
  v_mfma_f32_16x16x32_bf16 v[204:207], v[116:119], a[4:7], v[204:207]
  v_fma_f32 v208, |v198|, v182, v208
  v_mfma_f32_16x16x32_bf16 v[204:207], v[112:115], a[0:3], v[204:207]
  v_fma_f32 v208, |v199|, v183, v208
  s_waitcnt lgkmcnt(0)
  v_mfma_f32_16x16x32_bf16 v[192:195], v[0:3], a[16:19], v[128:131]
  v_fma_f32 v208, |v200|, v184, v208
  v_mfma_f32_16x16x32_bf16 v[192:195], v[4:7], a[20:23], v[192:195]
  v_fma_f32 v208, |v201|, v185, v208
  v_mfma_f32_16x16x32_bf16 v[192:195], v[8:11], a[24:27], v[192:195]
  v_fma_f32 v208, |v202|, v186, v208
  v_mfma_f32_16x16x32_bf16 v[192:195], v[12:15], a[28:31], v[192:195]
  v_fma_f32 v208, |v203|, v187, v208
  v_mfma_f32_16x16x32_bf16 v[196:199], v[28:31], a[28:31], v[132:135]
  v_fma_f32 v208, |v204|, v188, v208
  v_fma_f32 v208, |v205|, v189, v208
  v_mfma_f32_16x16x32_bf16 v[196:199], v[24:27], a[24:27], v[196:199]
  ds_read_b128 a[0:3], v214 offset:8192
  v_mfma_f32_16x16x32_bf16 v[196:199], v[20:23], a[20:23], v[196:199]
  v_fma_f32 v208, |v206|, v190, v208
  v_mfma_f32_16x16x32_bf16 v[196:199], v[16:19], a[16:19], v[196:199]
  v_fma_f32 v208, |v207|, v191, v208
  v_mfma_f32_16x16x32_bf16 v[200:203], v[32:35], a[16:19], v[136:139]
  v_mul_f32_e64 v209, |v192|, v160
  v_fma_f32 v209, |v193|, v161, v209
  v_mfma_f32_16x16x32_bf16 v[200:203], v[36:39], a[20:23], v[200:203]
  ds_read_b128 a[4:7], v215 offset:8192
  v_mfma_f32_16x16x32_bf16 v[200:203], v[40:43], a[24:27], v[200:203]
  v_fma_f32 v209, |v194|, v162, v209
  v_mfma_f32_16x16x32_bf16 v[200:203], v[44:47], a[28:31], v[200:203]
  v_fma_f32 v209, |v195|, v163, v209
  v_mfma_f32_16x16x32_bf16 v[204:207], v[60:63], a[28:31], v[140:143]
  v_fma_f32 v209, |v196|, v164, v209
  v_fma_f32 v209, |v197|, v165, v209
  v_mfma_f32_16x16x32_bf16 v[204:207], v[56:59], a[24:27], v[204:207]
  ds_read_b128 a[8:11], v216 offset:8192
  v_mfma_f32_16x16x32_bf16 v[204:207], v[52:55], a[20:23], v[204:207]
  v_fma_f32 v209, |v198|, v166, v209
  v_mfma_f32_16x16x32_bf16 v[204:207], v[48:51], a[16:19], v[204:207]
  v_fma_f32 v209, |v199|, v167, v209
  v_mfma_f32_16x16x32_bf16 v[192:195], v[64:67], a[16:19], v[144:147]
  v_fma_f32 v209, |v200|, v168, v209
  v_fma_f32 v209, |v201|, v169, v209
  v_mfma_f32_16x16x32_bf16 v[192:195], v[68:71], a[20:23], v[192:195]
  ds_read_b128 a[12:15], v217 offset:8192
  v_mfma_f32_16x16x32_bf16 v[192:195], v[72:75], a[24:27], v[192:195]
  v_fma_f32 v209, |v202|, v170, v209
  v_mfma_f32_16x16x32_bf16 v[192:195], v[76:79], a[28:31], v[192:195]
  v_fma_f32 v209, |v203|, v171, v209
  v_mfma_f32_16x16x32_bf16 v[196:199], v[92:95], a[28:31], v[148:151]
  v_fma_f32 v209, |v204|, v172, v209
  v_mfma_f32_16x16x32_bf16 v[196:199], v[88:91], a[24:27], v[196:199]
  v_fma_f32 v209, |v205|, v173, v209
  v_mfma_f32_16x16x32_bf16 v[196:199], v[84:87], a[20:23], v[196:199]
  v_fma_f32 v209, |v206|, v174, v209
  v_mfma_f32_16x16x32_bf16 v[196:199], v[80:83], a[16:19], v[196:199]
  v_fma_f32 v209, |v207|, v175, v209
  v_mfma_f32_16x16x32_bf16 v[200:203], v[96:99], a[16:19], v[152:155]
  v_fma_f32 v209, |v192|, v176, v209
  v_mfma_f32_16x16x32_bf16 v[200:203], v[100:103], a[20:23], v[200:203]
  v_fma_f32 v209, |v193|, v177, v209
  v_mfma_f32_16x16x32_bf16 v[200:203], v[104:107], a[24:27], v[200:203]
  v_fma_f32 v209, |v194|, v178, v209
  v_mfma_f32_16x16x32_bf16 v[200:203], v[108:111], a[28:31], v[200:203]
  v_fma_f32 v209, |v195|, v179, v209
  v_mfma_f32_16x16x32_bf16 v[204:207], v[124:127], a[28:31], v[156:159]
  v_fma_f32 v209, |v196|, v180, v209
  v_mfma_f32_16x16x32_bf16 v[204:207], v[120:123], a[24:27], v[204:207]
  v_fma_f32 v209, |v197|, v181, v209
  v_mfma_f32_16x16x32_bf16 v[204:207], v[116:119], a[20:23], v[204:207]
  v_fma_f32 v209, |v198|, v182, v209
  v_mfma_f32_16x16x32_bf16 v[204:207], v[112:115], a[16:19], v[204:207]
  v_fma_f32 v209, |v199|, v183, v209
  s_waitcnt lgkmcnt(0)
  v_mfma_f32_16x16x32_bf16 v[192:195], v[0:3], a[0:3], v[128:131]
  v_fma_f32 v209, |v200|, v184, v209
  v_mfma_f32_16x16x32_bf16 v[192:195], v[4:7], a[4:7], v[192:195]
  v_fma_f32 v209, |v201|, v185, v209
  v_mfma_f32_16x16x32_bf16 v[192:195], v[8:11], a[8:11], v[192:195]
  v_fma_f32 v209, |v202|, v186, v209
  v_mfma_f32_16x16x32_bf16 v[192:195], v[12:15], a[12:15], v[192:195]
  v_fma_f32 v209, |v203|, v187, v209
  v_mfma_f32_16x16x32_bf16 v[196:199], v[28:31], a[12:15], v[132:135]
  v_fma_f32 v209, |v204|, v188, v209
  v_fma_f32 v209, |v205|, v189, v209
  v_mfma_f32_16x16x32_bf16 v[196:199], v[24:27], a[8:11], v[196:199]
  ds_read_b128 a[16:19], v214 offset:12288
  v_mfma_f32_16x16x32_bf16 v[196:199], v[20:23], a[4:7], v[196:199]
  v_fma_f32 v209, |v206|, v190, v209
  v_mfma_f32_16x16x32_bf16 v[196:199], v[16:19], a[0:3], v[196:199]
  v_fma_f32 v209, |v207|, v191, v209
  v_mfma_f32_16x16x32_bf16 v[200:203], v[32:35], a[0:3], v[136:139]
  v_mul_f32_e64 v210, |v192|, v160
  v_fma_f32 v210, |v193|, v161, v210
  v_mfma_f32_16x16x32_bf16 v[200:203], v[36:39], a[4:7], v[200:203]
  ds_read_b128 a[20:23], v215 offset:12288
  v_mfma_f32_16x16x32_bf16 v[200:203], v[40:43], a[8:11], v[200:203]
  v_fma_f32 v210, |v194|, v162, v210
  v_mfma_f32_16x16x32_bf16 v[200:203], v[44:47], a[12:15], v[200:203]
  v_fma_f32 v210, |v195|, v163, v210
  v_mfma_f32_16x16x32_bf16 v[204:207], v[60:63], a[12:15], v[140:143]
  v_fma_f32 v210, |v196|, v164, v210
  v_fma_f32 v210, |v197|, v165, v210
  v_mfma_f32_16x16x32_bf16 v[204:207], v[56:59], a[8:11], v[204:207]
  ds_read_b128 a[24:27], v216 offset:12288
  v_mfma_f32_16x16x32_bf16 v[204:207], v[52:55], a[4:7], v[204:207]
  v_fma_f32 v210, |v198|, v166, v210
  v_mfma_f32_16x16x32_bf16 v[204:207], v[48:51], a[0:3], v[204:207]
  v_fma_f32 v210, |v199|, v167, v210
  v_mfma_f32_16x16x32_bf16 v[192:195], v[64:67], a[0:3], v[144:147]
  v_fma_f32 v210, |v200|, v168, v210
  v_fma_f32 v210, |v201|, v169, v210
  v_mfma_f32_16x16x32_bf16 v[192:195], v[68:71], a[4:7], v[192:195]
  ds_read_b128 a[28:31], v217 offset:12288
  v_mfma_f32_16x16x32_bf16 v[192:195], v[72:75], a[8:11], v[192:195]
  v_fma_f32 v210, |v202|, v170, v210
  v_mfma_f32_16x16x32_bf16 v[192:195], v[76:79], a[12:15], v[192:195]
  v_fma_f32 v210, |v203|, v171, v210
  v_mfma_f32_16x16x32_bf16 v[196:199], v[92:95], a[12:15], v[148:151]
  v_fma_f32 v210, |v204|, v172, v210
  v_mfma_f32_16x16x32_bf16 v[196:199], v[88:91], a[8:11], v[196:199]
  v_fma_f32 v210, |v205|, v173, v210
  v_mfma_f32_16x16x32_bf16 v[196:199], v[84:87], a[4:7], v[196:199]
  v_fma_f32 v210, |v206|, v174, v210
  v_mfma_f32_16x16x32_bf16 v[196:199], v[80:83], a[0:3], v[196:199]
  v_fma_f32 v210, |v207|, v175, v210
  v_mfma_f32_16x16x32_bf16 v[200:203], v[96:99], a[0:3], v[152:155]
  v_fma_f32 v210, |v192|, v176, v210
  v_mfma_f32_16x16x32_bf16 v[200:203], v[100:103], a[4:7], v[200:203]
  ds_read_b32 v222, v221
  v_mfma_f32_16x16x32_bf16 v[200:203], v[104:107], a[8:11], v[200:203]
  v_fma_f32 v210, |v193|, v177, v210
  v_fma_f32 v210, |v194|, v178, v210
  v_mfma_f32_16x16x32_bf16 v[200:203], v[108:111], a[12:15], v[200:203]
  v_fma_f32 v210, |v195|, v179, v210
  v_mfma_f32_16x16x32_bf16 v[204:207], v[124:127], a[12:15], v[156:159]
  v_fma_f32 v210, |v196|, v180, v210
  v_mfma_f32_16x16x32_bf16 v[204:207], v[120:123], a[8:11], v[204:207]
  v_fma_f32 v210, |v197|, v181, v210
  v_mfma_f32_16x16x32_bf16 v[204:207], v[116:119], a[4:7], v[204:207]
  v_fma_f32 v210, |v198|, v182, v210
  v_mfma_f32_16x16x32_bf16 v[204:207], v[112:115], a[0:3], v[204:207]
  v_fma_f32 v210, |v199|, v183, v210
  s_waitcnt lgkmcnt(0)
  s_bitcmp1_b32 s62, s61
  s_cbranch_scc0 L_tok
  v_readfirstlane_b32 s60, v222
  v_add_u32 v221, 4, v221
  s_cmp_ge_u32 s60, 4
  s_cbranch_scc1 L_tok
  v_subrev_u32 v221, 4, v221
  s_mov_b32 s79, 0
L_spinT_7:
  ds_read_b32 v222, v221 offset:0
  s_waitcnt lgkmcnt(0)
  v_readfirstlane_b32 s60, v222
  s_add_u32 s79, s79, 1
  s_cmp_ge_u32 s60, 4
  s_cbranch_scc1 L_spinxT_8
  s_cmp_gt_u32 s79, 0x100000
  s_cbranch_scc1 L_spinxT_8
  s_sleep 1
  s_branch L_spinT_7
L_spinxT_8:
  v_add_u32 v221, 4, v221
L_tok:
  v_mfma_f32_16x16x32_bf16 v[192:195], v[0:3], a[16:19], v[128:131]
  v_fma_f32 v210, |v200|, v184, v210
  v_mfma_f32_16x16x32_bf16 v[192:195], v[4:7], a[20:23], v[192:195]
  v_fma_f32 v210, |v201|, v185, v210
  v_mfma_f32_16x16x32_bf16 v[192:195], v[8:11], a[24:27], v[192:195]
  v_fma_f32 v210, |v202|, v186, v210
  v_mfma_f32_16x16x32_bf16 v[192:195], v[12:15], a[28:31], v[192:195]
  v_fma_f32 v210, |v203|, v187, v210
  v_mfma_f32_16x16x32_bf16 v[196:199], v[28:31], a[28:31], v[132:135]
  v_fma_f32 v210, |v204|, v188, v210
  v_fma_f32 v210, |v205|, v189, v210
  v_mfma_f32_16x16x32_bf16 v[196:199], v[24:27], a[24:27], v[196:199]
  ds_read_b128 a[0:3], v214 offset:16384
  v_mfma_f32_16x16x32_bf16 v[196:199], v[20:23], a[20:23], v[196:199]
  v_fma_f32 v210, |v206|, v190, v210
  v_mfma_f32_16x16x32_bf16 v[196:199], v[16:19], a[16:19], v[196:199]
  v_fma_f32 v210, |v207|, v191, v210
  v_mfma_f32_16x16x32_bf16 v[200:203], v[32:35], a[16:19], v[136:139]
  v_mul_f32_e64 v211, |v192|, v160
  v_fma_f32 v211, |v193|, v161, v211
  v_mfma_f32_16x16x32_bf16 v[200:203], v[36:39], a[20:23], v[200:203]
  ds_read_b128 a[4:7], v215 offset:16384
  v_mfma_f32_16x16x32_bf16 v[200:203], v[40:43], a[24:27], v[200:203]
  v_fma_f32 v211, |v194|, v162, v211
  v_permlane32_swap_b32 v208, v210
  v_mfma_f32_16x16x32_bf16 v[200:203], v[44:47], a[28:31], v[200:203]
  v_fma_f32 v211, |v195|, v163, v211
  v_mfma_f32_16x16x32_bf16 v[204:207], v[60:63], a[28:31], v[140:143]
  v_fma_f32 v211, |v196|, v164, v211
  v_fma_f32 v211, |v197|, v165, v211
  v_mfma_f32_16x16x32_bf16 v[204:207], v[56:59], a[24:27], v[204:207]
  ds_read_b128 a[8:11], v216 offset:16384
  v_mfma_f32_16x16x32_bf16 v[204:207], v[52:55], a[20:23], v[204:207]
  v_fma_f32 v211, |v198|, v166, v211
  v_add_f32 v212, v208, v210
  v_mfma_f32_16x16x32_bf16 v[204:207], v[48:51], a[16:19], v[204:207]
  v_fma_f32 v211, |v199|, v167, v211
  v_mfma_f32_16x16x32_bf16 v[192:195], v[64:67], a[16:19], v[144:147]
  v_fma_f32 v211, |v200|, v168, v211
  v_fma_f32 v211, |v201|, v169, v211
  v_mfma_f32_16x16x32_bf16 v[192:195], v[68:71], a[20:23], v[192:195]
  ds_read_b128 a[12:15], v217 offset:16384
  v_mfma_f32_16x16x32_bf16 v[192:195], v[72:75], a[24:27], v[192:195]
  v_fma_f32 v211, |v202|, v170, v211
  v_mfma_f32_16x16x32_bf16 v[192:195], v[76:79], a[28:31], v[192:195]
  v_fma_f32 v211, |v203|, v171, v211
  v_mfma_f32_16x16x32_bf16 v[196:199], v[92:95], a[28:31], v[148:151]
  v_fma_f32 v211, |v204|, v172, v211
  v_mfma_f32_16x16x32_bf16 v[196:199], v[88:91], a[24:27], v[196:199]
  v_fma_f32 v211, |v205|, v173, v211
  v_mfma_f32_16x16x32_bf16 v[196:199], v[84:87], a[20:23], v[196:199]
  v_fma_f32 v211, |v206|, v174, v211
  v_mfma_f32_16x16x32_bf16 v[196:199], v[80:83], a[16:19], v[196:199]
  v_fma_f32 v211, |v207|, v175, v211
  v_mfma_f32_16x16x32_bf16 v[200:203], v[96:99], a[16:19], v[152:155]
  v_fma_f32 v211, |v192|, v176, v211
  v_add_u32 v214, 16384, v214
  v_mfma_f32_16x16x32_bf16 v[200:203], v[100:103], a[20:23], v[200:203]
  v_fma_f32 v211, |v193|, v177, v211
  v_add_u32 v215, 16384, v215
  v_mfma_f32_16x16x32_bf16 v[200:203], v[104:107], a[24:27], v[200:203]
  v_fma_f32 v211, |v194|, v178, v211
  v_add_u32 v216, 16384, v216
  v_mfma_f32_16x16x32_bf16 v[200:203], v[108:111], a[28:31], v[200:203]
  v_fma_f32 v211, |v195|, v179, v211
  v_add_u32 v217, 16384, v217
  v_mfma_f32_16x16x32_bf16 v[204:207], v[124:127], a[28:31], v[156:159]
  v_fma_f32 v211, |v196|, v180, v211
  v_mfma_f32_16x16x32_bf16 v[204:207], v[120:123], a[24:27], v[204:207]
  v_fma_f32 v211, |v197|, v181, v211
  v_mfma_f32_16x16x32_bf16 v[204:207], v[116:119], a[20:23], v[204:207]
  v_fma_f32 v211, |v198|, v182, v211
  v_mfma_f32_16x16x32_bf16 v[204:207], v[112:115], a[16:19], v[204:207]
  v_fma_f32 v211, |v199|, v183, v211
  s_add_u32 s61, s61, 1
  s_cmp_lt_u32 s61, 8
  s_cbranch_scc1 L_mloop
  s_lshl_b32 s52, s26, 12
  s_add_u32 s52, s52, 134656
  v_subrev_u32 v131, 154624, v218
  v_and_b32 v132, 0xff, v131
  v_lshl_add_u32 v131, v132, 1, s52
  v_mov_b32 v133, 130592
  ds_read_b64 v[128:129], v131
  ds_read_b32 v130, v133
  s_mov_b32 s36, s24
  s_mov_b32 s37, s25
  s_mov_b32 s38, 2048000
  s_mov_b32 s39, 0x20000
  s_lshl_b32 s53, s27, 11
  s_add_u32 s53, s53, 1792
  s_mov_b32 s54, 1060678203
  v_fma_f32 v211, |v200|, v184, v211
  v_fma_f32 v211, |v201|, v185, v211
  v_fma_f32 v211, |v202|, v186, v211
  v_fma_f32 v211, |v203|, v187, v211
  v_fma_f32 v211, |v204|, v188, v211
  v_fma_f32 v211, |v205|, v189, v211
  v_fma_f32 v211, |v206|, v190, v211
  v_fma_f32 v211, |v207|, v191, v211
  s_nop 1
  v_permlane32_swap_b32 v209, v211
  s_nop 1
  v_add_f32 v213, v209, v211
  v_add_u32 v220, 1, v220
  s_nop 0
  v_permlane16_swap_b32 v212, v213
  s_nop 1
  v_add_f32 v212, v212, v213
  s_waitcnt lgkmcnt(0)
  v_add_f32 v212, v212, v128
  v_fma_f32 v212, v212, s54, v130
  v_cvt_pk_bf16_f32 v212, v212, v129
  v_max_u32 v212, 1, v212
  buffer_store_dword v212, v132, s[36:39], s53 offen sc1
  ds_write_b32 v219, v220
  s_waitcnt lgkmcnt(0)
  s_endpgm
L_help:
  v_lshrrev_b32 v222, 4, v223
  v_and_b32 v221, 15, v223
  v_lshlrev_b32 v220, 2, v223
  v_mov_b32 v41, 130560
  v_mov_b32 v44, 1
  v_mov_b32 v149, 0
  v_add_u32 v150, 130560, v220
  s_mov_b64 exec, 0xffff
  ds_write_b32 v150, v149
  ds_write_b32 v150, v149 offset:320
  s_mov_b64 exec, -1
  s_cmp_ge_u32 s2, 250
  s_cselect_b32 s67, 1, 0
  s_waitcnt lgkmcnt(0)
  s_cbranch_scc1 L_hs0
  s_barrier
L_hs0:
  v_lshlrev_b32 v145, 8, v222
  v_xor_b32 v146, v222, v221
  v_lshl_add_u32 v36, v146, 4, v145
  v_xor_b32 v37, 64, v36
  v_xor_b32 v38, 128, v36
  v_xor_b32 v39, 192, v36
  s_lshl_b32 s100, s2, 10
  s_lshl_b32 s101, s26, 12
  s_add_u32 s100, s100, s101
  s_mov_b32 m0, s101
  s_mov_b32 s63, 0
  s_mov_b32 s40, s24
  s_or_b32 s41, s25, 0x40000
  s_mov_b32 s42, 512000
  s_mov_b32 s43, 0x20000
  s_mov_b32 s48, s20
  s_mov_b32 s49, s21
  s_mov_b32 s50, 8192
  s_mov_b32 s51, 0x20000
  s_mov_b32 s36, s24
  s_mov_b32 s37, s25
  s_mov_b32 s38, 2048000
  s_mov_b32 s39, 0x20000
  s_mov_b32 s70, 0x01f401f4
  s_mov_b32 s71, 0x03e803e8
  s_mov_b32 s72, 0x000f000f
  s_mov_b32 s73, 0x00030003
  s_lshl_b32 s59, s26, 11
  s_add_u32 s59, s59, 155648
  v_add_u32 v46, s59, v220
  s_add_u32 s74, s59, 1536
  v_lshlrev_b32 v45, 5, v222
  v_add_u32 v45, s74, v45
  s_lshr_b32 s75, s59, 2
  s_lshl_b32 s59, s26, 8
  s_add_u32 s59, s59, 147456
  v_add_u32 v43, s59, v220
  s_lshl_b32 s59, s26, 12
  s_add_u32 s59, s59, 131072
  v_lshlrev_b32 v216, 3, v223
  v_add_u32 v216, s59, v216
  s_lshl_b32 s59, s27, 11
  v_add_u32 v47, s59, v220
  s_lshl_b32 s59, s26, 2
  s_add_u32 s59, s59, 130560
  v_mov_b32 v42, s59
  v_mul_u32_u24 v218, 31, v223
  v_subrev_u32 v144, 250, v218
  v_min_u32 v218, v218, v144
  v_lshlrev_b32 v218, 11, v218
  v_add_u32 v218, 63, v218
  v_mov_b32 v219, 1
  v_mov_b32 v72, 0
  v_mov_b32 v73, 0
  v_mov_b32 v74, 0
  v_mov_b32 v75, 0
  v_mov_b32 v76, 0
  v_mov_b32 v77, 0xff80
  v_mov_b32 v78, 0
  v_mov_b32 v79, 0
  v_mov_b32 v80, 0
  v_mov_b32 v81, 0
  v_mov_b32 v82, 0
  v_mov_b32 v83, 0xff80
  v_mov_b32 v84, 0
  v_mov_b32 v85, 0
  v_mov_b32 v86, 0
  v_mov_b32 v87, 0
  v_mov_b32 v88, 0
  v_mov_b32 v89, 0xff80
  v_mov_b32 v90, 0
  v_mov_b32 v91, 0
  v_mov_b32 v92, 0
  v_mov_b32 v93, 0
  v_mov_b32 v94, 0
  v_mov_b32 v95, 0xff80
  s_mov_b64 exec, 0x1f
  v_mov_b32 v77, 0
  v_mov_b32 v83, 0
  v_mov_b32 v89, 0
  v_mov_b32 v95, 0
  s_mov_b64 exec, -1
  v_and_b32 v151, 3, v221
  v_lshlrev_b32 v151, 2, v151
  v_lshrrev_b32 v152, 2, v221
  v_or_b32 v151, v151, v152
  v_xor_b32 v151, v151, v222
  v_lshlrev_b32 v152, 8, v221
  v_lshl_add_u32 v152, v151, 4, v152
  s_lshl_b32 s59, s26, 13
  s_add_u32 s59, s59, 131072
  v_add_u32 v192, s59, v152
  v_xor_b32 v193, 64, v192
  v_xor_b32 v194, 128, v192
  v_xor_b32 v195, 192, v192
  v_lshlrev_b32 v196, 4, v222
  v_add_u32 v196, 130624, v196
  v_add_u32 v197, 130624, v220
  v_lshlrev_b32 v198, 3, v223
  v_add_u32 v215, 130048, v198
  v_add_u32 v198, 129024, v198
  s_lshl_b32 s59, s26, 7
  s_add_u32 s59, s59, 130048
  v_lshlrev_b32 v199, 4, v222
  v_add_u32 v199, s59, v199
  v_lshlrev_b32 v155, 8, v221
  s_lshl_b32 s59, s26, 15
  v_add_u32 v155, s59, v155
  v_or_b32 v154, 0, v222
  v_xor_b32 v154, v154, v221
  v_lshl_add_u32 v208, v154, 4, v155
  v_or_b32 v154, 4, v222
  v_xor_b32 v154, v154, v221
  v_lshl_add_u32 v209, v154, 4, v155
  v_or_b32 v154, 8, v222
  v_xor_b32 v154, v154, v221
  v_lshl_add_u32 v210, v154, 4, v155
  v_or_b32 v154, 12, v222
  v_xor_b32 v154, v154, v221
  v_lshl_add_u32 v211, v154, 4, v155
  v_and_b32 v212, 1, v222
  v_lshlrev_b32 v212, 13, v212
  v_lshl_add_u32 v212, v221, 3, v212
  s_lshl_b32 s59, s26, 10
  s_add_u32 s59, s59, 131072
  v_add_u32 v212, s59, v212
  v_and_b32 v213, 7, v223
  v_mul_u32_u24 v213, 272, v213
  v_lshl_add_u32 v213, v222, 4, v213
  v_add_u32 v213, 155648, v213
  v_lshrrev_b32 v214, 2, v223
  v_xor_b32 v214, s26, v214
  v_lshlrev_b32 v214, 4, v214
  v_and_b32 v145, 3, v223
  v_lshl_add_u32 v214, v145, 2, v214
  s_lshl_b32 s59, s26, 8
  v_add_u32 v214, s59, v214
  s_mul_i32 s59, s26, 544
  s_add_u32 s59, s59, 155648
  v_add_u32 v217, s59, v220
  s_lshl_b32 s55, s27, 11
  s_mov_b32 s69, 1060678203
  s_cmp_eq_u32 s67, 1
  s_cbranch_scc1 L_hs1
  s_mov_b32 s28, s6
  s_mov_b32 s29, s7
  s_mov_b32 s30, 256000
  s_mov_b32 s31, 0x20000
  s_mov_b32 s56, s14
  s_mov_b32 s57, s15
  s_mov_b32 s58, 256
  s_mov_b32 s59, 0x20000
  s_mov_b32 s60, s16
  s_mov_b32 s61, s17
  s_mov_b32 s62, 256
  s_mov_b32 s63, 0x20000
  buffer_load_dword v33, v220, s[60:63], 0 offen
  buffer_load_dword v32, v220, s[56:59], 0 offen
  s_sub_u32 s58, s100, 256000
  s_min_u32 s57, s100, s58
  s_add_u32 s100, s100, 1024
  buffer_load_dwordx4 v36, s[28:31], s57 offen lds
  s_add_u32 m0, m0, 1024
  s_sub_u32 s58, s100, 256000
  s_min_u32 s57, s100, s58
  s_add_u32 s100, s100, 1024
  buffer_load_dwordx4 v37, s[28:31], s57 offen lds
  s_add_u32 m0, m0, 1024
  s_sub_u32 s58, s100, 256000
  s_min_u32 s57, s100, s58
  s_add_u32 s100, s100, 1024
  buffer_load_dwordx4 v38, s[28:31], s57 offen lds
  s_add_u32 m0, m0, 1024
  s_sub_u32 s58, s100, 256000
  s_min_u32 s57, s100, s58
  s_add_u32 s100, s100, 13312
  buffer_load_dwordx4 v39, s[28:31], s57 offen lds
  s_add_u32 m0, m0, 13312
L_hs1:
  s_mov_b32 s44, s4
  s_mov_b32 s45, s5
  s_mov_b32 s46, 425984
  s_mov_b32 s47, 0x20000
  s_lshl_b32 s52, s2, 2
  s_add_u32 s52, s52, s26
  s_mul_i32 s52, s52, 416
  buffer_load_dword v0, v220, s[44:47], s52 offen offset:0
  buffer_load_dword v1, v220, s[44:47], s52 offen offset:104
  buffer_load_dword v2, v220, s[44:47], s52 offen offset:208
  buffer_load_dword v3, v220, s[44:47], s52 offen offset:312
  s_mov_b32 s52, s8
  s_mov_b32 s53, s9
  s_mov_b32 s54, 1300
  s_mov_b32 s55, 0x20000
  v_lshlrev_b32 v174, 4, v223
  v_lshlrev_b32 v175, 3, v223
  buffer_load_dwordx4 v[4:7], v174, s[52:55], 0 offen
  buffer_load_dwordx2 v[8:9], v175, s[52:55], 0 offen offset:1024
  s_mov_b32 s52, s10
  s_mov_b32 s53, s11
  s_mov_b32 s54, 1300
  s_mov_b32 s55, 0x20000
  buffer_load_dwordx4 v[10:13], v174, s[52:55], 0 offen
  buffer_load_dwordx2 v[14:15], v175, s[52:55], 0 offen offset:1024
  s_lshl_b32 s55, s27, 11
  s_cmp_eq_u32 s67, 1
  s_cbranch_scc1 L_hspecial
  s_mov_b32 s64, s18
  s_mov_b32 s65, s19
  s_mov_b32 s66, 256
  s_mov_b32 s67, 0x20000
  s_waitcnt vmcnt(12)
  s_setprio 0
  v_lshlrev_b32 v120, 16, v32
  v_and_b32 v121, 0xffff0000, v32
  v_lshlrev_b32 v122, 16, v33
  v_and_b32 v123, 0xffff0000, v33
  s_cmp_lg_u32 s26, 0
  s_cbranch_scc1 L_nobias
  ds_write_b64 v198, v[120:121]
  ds_write_b64 v198, v[122:123] offset:512
  s_mov_b64 exec, 1
  ds_add_u32 v41, v44 offset:24
  s_mov_b64 exec, -1
L_nobias:
  ds_write_b32 v197, v33
  s_sub_u32 s58, s100, 256000
  s_min_u32 s57, s100, s58
  s_add_u32 s100, s100, 1024
  buffer_load_dwordx4 v36, s[28:31], s57 offen lds
  s_add_u32 m0, m0, 1024
  s_sub_u32 s58, s100, 256000
  s_min_u32 s57, s100, s58
  s_add_u32 s100, s100, 1024
  buffer_load_dwordx4 v37, s[28:31], s57 offen lds
  s_add_u32 m0, m0, 1024
  s_sub_u32 s58, s100, 256000
  s_min_u32 s57, s100, s58
  s_add_u32 s100, s100, 1024
  buffer_load_dwordx4 v38, s[28:31], s57 offen lds
  s_add_u32 m0, m0, 1024
  s_sub_u32 s58, s100, 256000
  s_min_u32 s57, s100, s58
  s_add_u32 s100, s100, 13312
  buffer_load_dwordx4 v39, s[28:31], s57 offen lds
  s_add_u32 m0, m0, 13312
  v_mul_f32_e64 v124, -|v120|, v122
  v_fma_f32 v124, -|v121|, v123, v124
  s_setprio 2
  s_waitcnt vmcnt(4)
  s_mov_b64 exec, 1
  ds_add_u32 v41, v44 offset:24
  s_mov_b64 exec, -1
  v_lshlrev_b32 v4, 2, v4
  v_lshlrev_b32 v10, 2, v10
  s_sub_u32 s58, s100, 256000
  s_min_u32 s57, s100, s58
  s_add_u32 s100, s100, 1024
  buffer_load_dwordx4 v36, s[28:31], s57 offen lds
  s_add_u32 m0, m0, 1024
  v_lshlrev_b32 v5, 2, v5
  v_lshlrev_b32 v11, 2, v11
  v_lshlrev_b32 v6, 2, v6
  v_lshlrev_b32 v12, 2, v12
  v_lshlrev_b32 v7, 2, v7
  v_lshlrev_b32 v13, 2, v13
  v_lshlrev_b32 v8, 2, v8
  v_lshlrev_b32 v14, 2, v14
  s_sub_u32 s58, s100, 256000
  s_min_u32 s57, s100, s58
  s_add_u32 s100, s100, 1024
  buffer_load_dwordx4 v37, s[28:31], s57 offen lds
  s_add_u32 m0, m0, 1024
  v_lshlrev_b32 v9, 2, v9
  v_lshlrev_b32 v15, 2, v15
  v_lshl_or_b32 v0, v1, 16, v0
  v_lshl_or_b32 v2, v3, 16, v2
  ds_bpermute_b32 v144, v4, v0
  ds_bpermute_b32 v145, v10, v0
  ds_bpermute_b32 v146, v5, v0
  ds_bpermute_b32 v147, v11, v0
  s_sub_u32 s58, s100, 256000
  s_min_u32 s57, s100, s58
  s_add_u32 s100, s100, 1024
  buffer_load_dwordx4 v38, s[28:31], s57 offen lds
  s_add_u32 m0, m0, 1024
  ds_bpermute_b32 v148, v6, v0
  ds_bpermute_b32 v149, v12, v0
  ds_bpermute_b32 v150, v7, v0
  ds_bpermute_b32 v151, v13, v0
  ds_bpermute_b32 v152, v8, v0
  ds_bpermute_b32 v153, v14, v0
  ds_bpermute_b32 v154, v9, v0
  ds_bpermute_b32 v155, v15, v0
  s_sub_u32 s58, s100, 256000
  s_min_u32 s57, s100, s58
  s_add_u32 s100, s100, 13312
  buffer_load_dwordx4 v39, s[28:31], s57 offen lds
  s_add_u32 m0, m0, 13312
  s_waitcnt lgkmcnt(10)
  ds_bpermute_b32 v156, v4, v2
  ds_bpermute_b32 v157, v10, v2
  v_pk_min_u16 v168, v144, v145
  v_pk_max_u16 v169, v144, v145
  v_pk_sub_u16 v170, v169, v168
  v_pk_sub_i16 v171, s70, v170
  v_pk_sub_u16 v144, s71, v170
  s_sub_u32 s58, s100, 256000
  s_min_u32 s57, s100, s58
  s_add_u32 s100, s100, 1024
  buffer_load_dwordx4 v36, s[28:31], s57 offen lds
  s_add_u32 m0, m0, 1024
  v_pk_ashrrev_i16 v171, s72, v171
  v_bfi_b32 v168, v171, v169, v168
  v_bfi_b32 v170, v171, v144, v170
  v_and_b32 v169, s73, v168
  v_pk_add_u16 v170, v170, v169
  v_lshlrev_b32_sdwa v48, 9, v168 dst_sel:DWORD dst_unused:UNUSED_PAD src0_sel:DWORD src1_sel:WORD_0
  v_lshlrev_b32_sdwa v54, 9, v168 dst_sel:DWORD dst_unused:UNUSED_PAD src0_sel:DWORD src1_sel:WORD_1
  v_add_u32_sdwa v48, v48, v170 dst_sel:DWORD dst_unused:UNUSED_PAD src0_sel:DWORD src1_sel:WORD_0
  s_sub_u32 s58, s100, 256000
  s_min_u32 s57, s100, s58
  s_add_u32 s100, s100, 1024
  buffer_load_dwordx4 v37, s[28:31], s57 offen lds
  s_add_u32 m0, m0, 1024
  v_add_u32_sdwa v54, v54, v170 dst_sel:DWORD dst_unused:UNUSED_PAD src0_sel:DWORD src1_sel:WORD_1
  v_lshrrev_b32 v96, 4, v170
  v_lshrrev_b32 v102, 20, v170
  v_and_or_b32 v96, v96, 28, v45
  v_and_or_b32 v102, v102, 28, v45
  s_waitcnt lgkmcnt(10)
  ds_bpermute_b32 v158, v5, v2
  ds_bpermute_b32 v159, v11, v2
  s_sub_u32 s58, s100, 256000
  s_min_u32 s57, s100, s58
  s_add_u32 s100, s100, 1024
  buffer_load_dwordx4 v38, s[28:31], s57 offen lds
  s_add_u32 m0, m0, 1024
  v_pk_min_u16 v168, v146, v147
  v_pk_max_u16 v169, v146, v147
  v_pk_sub_u16 v170, v169, v168
  v_pk_sub_i16 v171, s70, v170
  v_pk_sub_u16 v146, s71, v170
  v_pk_ashrrev_i16 v171, s72, v171
  v_bfi_b32 v168, v171, v169, v168
  v_bfi_b32 v170, v171, v146, v170
  s_sub_u32 s58, s100, 256000
  s_min_u32 s57, s100, s58
  s_add_u32 s100, s100, 13312
  buffer_load_dwordx4 v39, s[28:31], s57 offen lds
  s_add_u32 m0, m0, 13312
  v_and_b32 v169, s73, v168
  v_pk_add_u16 v170, v170, v169
  v_lshlrev_b32_sdwa v49, 9, v168 dst_sel:DWORD dst_unused:UNUSED_PAD src0_sel:DWORD src1_sel:WORD_0
  v_lshlrev_b32_sdwa v55, 9, v168 dst_sel:DWORD dst_unused:UNUSED_PAD src0_sel:DWORD src1_sel:WORD_1
  v_add_u32_sdwa v49, v49, v170 dst_sel:DWORD dst_unused:UNUSED_PAD src0_sel:DWORD src1_sel:WORD_0
  v_add_u32_sdwa v55, v55, v170 dst_sel:DWORD dst_unused:UNUSED_PAD src0_sel:DWORD src1_sel:WORD_1
  v_lshrrev_b32 v97, 4, v170
  v_lshrrev_b32 v103, 20, v170
  s_sub_u32 s58, s100, 256000
  s_min_u32 s57, s100, s58
  s_add_u32 s100, s100, 1024
  buffer_load_dwordx4 v36, s[28:31], s57 offen lds
  s_add_u32 m0, m0, 1024
  v_and_or_b32 v97, v97, 28, v45
  v_and_or_b32 v103, v103, 28, v45
  s_waitcnt lgkmcnt(10)
  ds_bpermute_b32 v160, v6, v2
  ds_bpermute_b32 v161, v12, v2
  v_pk_min_u16 v168, v148, v149
  v_pk_max_u16 v169, v148, v149
  v_pk_sub_u16 v170, v169, v168
  s_sub_u32 s58, s100, 256000
  s_min_u32 s57, s100, s58
  s_add_u32 s100, s100, 1024
  buffer_load_dwordx4 v37, s[28:31], s57 offen lds
  s_add_u32 m0, m0, 1024
  v_pk_sub_i16 v171, s70, v170
  v_pk_sub_u16 v148, s71, v170
  v_pk_ashrrev_i16 v171, s72, v171
  v_bfi_b32 v168, v171, v169, v168
  v_bfi_b32 v170, v171, v148, v170
  v_and_b32 v169, s73, v168
  v_pk_add_u16 v170, v170, v169
  v_lshlrev_b32_sdwa v50, 9, v168 dst_sel:DWORD dst_unused:UNUSED_PAD src0_sel:DWORD src1_sel:WORD_0
  s_sub_u32 s58, s100, 256000
  s_min_u32 s57, s100, s58
  s_add_u32 s100, s100, 1024
  buffer_load_dwordx4 v38, s[28:31], s57 offen lds
  s_add_u32 m0, m0, 1024
  v_lshlrev_b32_sdwa v56, 9, v168 dst_sel:DWORD dst_unused:UNUSED_PAD src0_sel:DWORD src1_sel:WORD_1
  v_add_u32_sdwa v50, v50, v170 dst_sel:DWORD dst_unused:UNUSED_PAD src0_sel:DWORD src1_sel:WORD_0
  v_add_u32_sdwa v56, v56, v170 dst_sel:DWORD dst_unused:UNUSED_PAD src0_sel:DWORD src1_sel:WORD_1
  v_lshrrev_b32 v98, 4, v170
  v_lshrrev_b32 v104, 20, v170
  v_and_or_b32 v98, v98, 28, v45
  v_and_or_b32 v104, v104, 28, v45
  s_waitcnt lgkmcnt(10)
  s_sub_u32 s58, s100, 256000
  s_min_u32 s57, s100, s58
  s_add_u32 s100, s100, 13312
  buffer_load_dwordx4 v39, s[28:31], s57 offen lds
  s_add_u32 m0, m0, 13312
  ds_bpermute_b32 v162, v7, v2
  ds_bpermute_b32 v163, v13, v2
  v_pk_min_u16 v168, v150, v151
  v_pk_max_u16 v169, v150, v151
  v_pk_sub_u16 v170, v169, v168
  v_pk_sub_i16 v171, s70, v170
  v_pk_sub_u16 v150, s71, v170
  v_pk_ashrrev_i16 v171, s72, v171
  s_sub_u32 s58, s100, 256000
  s_min_u32 s57, s100, s58
  s_add_u32 s100, s100, 1024
  buffer_load_dwordx4 v36, s[28:31], s57 offen lds
  s_add_u32 m0, m0, 1024
  v_bfi_b32 v168, v171, v169, v168
  v_bfi_b32 v170, v171, v150, v170
  v_and_b32 v169, s73, v168
  v_pk_add_u16 v170, v170, v169
  v_lshlrev_b32_sdwa v51, 9, v168 dst_sel:DWORD dst_unused:UNUSED_PAD src0_sel:DWORD src1_sel:WORD_0
  v_lshlrev_b32_sdwa v57, 9, v168 dst_sel:DWORD dst_unused:UNUSED_PAD src0_sel:DWORD src1_sel:WORD_1
  v_add_u32_sdwa v51, v51, v170 dst_sel:DWORD dst_unused:UNUSED_PAD src0_sel:DWORD src1_sel:WORD_0
  v_add_u32_sdwa v57, v57, v170 dst_sel:DWORD dst_unused:UNUSED_PAD src0_sel:DWORD src1_sel:WORD_1
  s_sub_u32 s58, s100, 256000
  s_min_u32 s57, s100, s58
  s_add_u32 s100, s100, 1024
  buffer_load_dwordx4 v37, s[28:31], s57 offen lds
  s_add_u32 m0, m0, 1024
  v_lshrrev_b32 v99, 4, v170
  v_lshrrev_b32 v105, 20, v170
  v_and_or_b32 v99, v99, 28, v45
  v_and_or_b32 v105, v105, 28, v45
  s_waitcnt lgkmcnt(10)
  ds_bpermute_b32 v164, v8, v2
  ds_bpermute_b32 v165, v14, v2
  v_pk_min_u16 v168, v152, v153
  s_sub_u32 s58, s100, 256000
  s_min_u32 s57, s100, s58
  s_add_u32 s100, s100, 1024
  buffer_load_dwordx4 v38, s[28:31], s57 offen lds
  s_add_u32 m0, m0, 1024
  v_pk_max_u16 v169, v152, v153
  s_waitcnt vmcnt(7)
  s_mov_b64 exec, 1
  ds_add_u32 v41, v44 offset:48
  s_mov_b64 exec, -1
  v_pk_sub_u16 v170, v169, v168
  v_pk_sub_i16 v171, s70, v170
  v_pk_sub_u16 v152, s71, v170
  v_pk_ashrrev_i16 v171, s72, v171
  v_bfi_b32 v168, v171, v169, v168
  v_bfi_b32 v170, v171, v152, v170
  v_and_b32 v169, s73, v168
  s_sub_u32 s58, s100, 256000
  s_min_u32 s57, s100, s58
  s_add_u32 s100, s100, 13312
  buffer_load_dwordx4 v39, s[28:31], s57 offen lds
  s_add_u32 m0, m0, 13312
  v_pk_add_u16 v170, v170, v169
  v_lshlrev_b32_sdwa v52, 9, v168 dst_sel:DWORD dst_unused:UNUSED_PAD src0_sel:DWORD src1_sel:WORD_0
  v_lshlrev_b32_sdwa v58, 9, v168 dst_sel:DWORD dst_unused:UNUSED_PAD src0_sel:DWORD src1_sel:WORD_1
  v_add_u32_sdwa v52, v52, v170 dst_sel:DWORD dst_unused:UNUSED_PAD src0_sel:DWORD src1_sel:WORD_0
  v_add_u32_sdwa v58, v58, v170 dst_sel:DWORD dst_unused:UNUSED_PAD src0_sel:DWORD src1_sel:WORD_1
  v_lshrrev_b32 v100, 4, v170
  v_lshrrev_b32 v106, 20, v170
  v_and_or_b32 v100, v100, 28, v45
  s_sub_u32 s58, s100, 256000
  s_min_u32 s57, s100, s58
  s_add_u32 s100, s100, 1024
  buffer_load_dwordx4 v36, s[28:31], s57 offen lds
  s_add_u32 m0, m0, 1024
  v_and_or_b32 v106, v106, 28, v45
  s_waitcnt lgkmcnt(10)
  ds_bpermute_b32 v166, v9, v2
  ds_bpermute_b32 v167, v15, v2
  v_pk_min_u16 v168, v154, v155
  v_pk_max_u16 v169, v154, v155
  v_pk_sub_u16 v170, v169, v168
  v_pk_sub_i16 v171, s70, v170
  s_sub_u32 s58, s100, 256000
  s_min_u32 s57, s100, s58
  s_add_u32 s100, s100, 1024
  buffer_load_dwordx4 v37, s[28:31], s57 offen lds
  s_add_u32 m0, m0, 1024
  v_pk_sub_u16 v154, s71, v170
  v_pk_ashrrev_i16 v171, s72, v171
  v_bfi_b32 v168, v171, v169, v168
  v_bfi_b32 v170, v171, v154, v170
  v_and_b32 v169, s73, v168
  v_pk_add_u16 v170, v170, v169
  v_lshlrev_b32_sdwa v53, 9, v168 dst_sel:DWORD dst_unused:UNUSED_PAD src0_sel:DWORD src1_sel:WORD_0
  v_lshlrev_b32_sdwa v59, 9, v168 dst_sel:DWORD dst_unused:UNUSED_PAD src0_sel:DWORD src1_sel:WORD_1
  s_sub_u32 s58, s100, 256000
  s_min_u32 s57, s100, s58
  s_add_u32 s100, s100, 1024
  buffer_load_dwordx4 v38, s[28:31], s57 offen lds
  s_add_u32 m0, m0, 1024
  v_add_u32_sdwa v53, v53, v170 dst_sel:DWORD dst_unused:UNUSED_PAD src0_sel:DWORD src1_sel:WORD_0
  v_add_u32_sdwa v59, v59, v170 dst_sel:DWORD dst_unused:UNUSED_PAD src0_sel:DWORD src1_sel:WORD_1
  v_lshrrev_b32 v101, 4, v170
  v_lshrrev_b32 v107, 20, v170
  v_and_or_b32 v101, v101, 28, v45
  v_and_or_b32 v107, v107, 28, v45
  s_waitcnt lgkmcnt(10)
  v_pk_min_u16 v168, v156, v157
  s_sub_u32 s58, s100, 256000
  s_min_u32 s57, s100, s58
  s_add_u32 s100, s100, 13312
  buffer_load_dwordx4 v39, s[28:31], s57 offen lds
  s_add_u32 m0, m0, 13312
  v_pk_max_u16 v169, v156, v157
  v_pk_sub_u16 v170, v169, v168
  v_pk_sub_i16 v171, s70, v170
  v_pk_sub_u16 v156, s71, v170
  v_pk_ashrrev_i16 v171, s72, v171
  v_bfi_b32 v168, v171, v169, v168
  v_bfi_b32 v170, v171, v156, v170
  v_and_b32 v169, s73, v168
  s_sub_u32 s58, s100, 256000
  s_min_u32 s57, s100, s58
  s_add_u32 s100, s100, 1024
  buffer_load_dwordx4 v36, s[28:31], s57 offen lds
  s_add_u32 m0, m0, 1024
  v_pk_add_u16 v170, v170, v169
  v_lshlrev_b32_sdwa v60, 9, v168 dst_sel:DWORD dst_unused:UNUSED_PAD src0_sel:DWORD src1_sel:WORD_0
  v_lshlrev_b32_sdwa v66, 9, v168 dst_sel:DWORD dst_unused:UNUSED_PAD src0_sel:DWORD src1_sel:WORD_1
  v_add_u32_sdwa v60, v60, v170 dst_sel:DWORD dst_unused:UNUSED_PAD src0_sel:DWORD src1_sel:WORD_0
  v_add_u32_sdwa v66, v66, v170 dst_sel:DWORD dst_unused:UNUSED_PAD src0_sel:DWORD src1_sel:WORD_1
  v_lshrrev_b32 v108, 4, v170
  v_lshrrev_b32 v114, 20, v170
  v_and_or_b32 v108, v108, 28, v45
  s_sub_u32 s58, s100, 256000
  s_min_u32 s57, s100, s58
  s_add_u32 s100, s100, 1024
  buffer_load_dwordx4 v37, s[28:31], s57 offen lds
  s_add_u32 m0, m0, 1024
  v_and_or_b32 v114, v114, 28, v45
  s_waitcnt lgkmcnt(8)
  v_pk_min_u16 v168, v158, v159
  v_pk_max_u16 v169, v158, v159
  v_pk_sub_u16 v170, v169, v168
  v_pk_sub_i16 v171, s70, v170
  v_pk_sub_u16 v158, s71, v170
  v_pk_ashrrev_i16 v171, s72, v171
  s_sub_u32 s58, s100, 256000
  s_min_u32 s57, s100, s58
  s_add_u32 s100, s100, 1024
  s_cmp_eq_u32 s26, 3
  s_cbranch_scc1 L_skipdma_2
  buffer_load_dwordx4 v38, s[28:31], s57 offen lds
L_skipdma_2:
  s_add_u32 m0, m0, 1024
  v_bfi_b32 v168, v171, v169, v168
  v_bfi_b32 v170, v171, v158, v170
  v_and_b32 v169, s73, v168
  v_pk_add_u16 v170, v170, v169
  v_lshlrev_b32_sdwa v61, 9, v168 dst_sel:DWORD dst_unused:UNUSED_PAD src0_sel:DWORD src1_sel:WORD_0
  v_lshlrev_b32_sdwa v67, 9, v168 dst_sel:DWORD dst_unused:UNUSED_PAD src0_sel:DWORD src1_sel:WORD_1
  v_add_u32_sdwa v61, v61, v170 dst_sel:DWORD dst_unused:UNUSED_PAD src0_sel:DWORD src1_sel:WORD_0
  v_add_u32_sdwa v67, v67, v170 dst_sel:DWORD dst_unused:UNUSED_PAD src0_sel:DWORD src1_sel:WORD_1
  s_sub_u32 s58, s100, 256000
  s_min_u32 s57, s100, s58
  s_add_u32 s100, s100, 13312
  s_cmp_eq_u32 s26, 3
  s_cbranch_scc1 L_skipdma_3
  buffer_load_dwordx4 v39, s[28:31], s57 offen lds
L_skipdma_3:
  s_add_u32 m0, m0, 13312
  v_lshrrev_b32 v109, 4, v170
  v_lshrrev_b32 v115, 20, v170
  v_and_or_b32 v109, v109, 28, v45
  v_and_or_b32 v115, v115, 28, v45
  s_waitcnt lgkmcnt(6)
  v_pk_min_u16 v168, v160, v161
  v_pk_max_u16 v169, v160, v161
  v_pk_sub_u16 v170, v169, v168
  v_pk_sub_i16 v171, s70, v170
  v_pk_sub_u16 v160, s71, v170
  v_pk_ashrrev_i16 v171, s72, v171
  v_bfi_b32 v168, v171, v169, v168
  v_bfi_b32 v170, v171, v160, v170
  v_and_b32 v169, s73, v168
  v_pk_add_u16 v170, v170, v169
  v_lshlrev_b32_sdwa v62, 9, v168 dst_sel:DWORD dst_unused:UNUSED_PAD src0_sel:DWORD src1_sel:WORD_0
  v_lshlrev_b32_sdwa v68, 9, v168 dst_sel:DWORD dst_unused:UNUSED_PAD src0_sel:DWORD src1_sel:WORD_1
  v_add_u32_sdwa v62, v62, v170 dst_sel:DWORD dst_unused:UNUSED_PAD src0_sel:DWORD src1_sel:WORD_0
  v_add_u32_sdwa v68, v68, v170 dst_sel:DWORD dst_unused:UNUSED_PAD src0_sel:DWORD src1_sel:WORD_1
  v_lshrrev_b32 v110, 4, v170
  v_lshrrev_b32 v116, 20, v170
  v_and_or_b32 v110, v110, 28, v45
  v_and_or_b32 v116, v116, 28, v45
  s_waitcnt lgkmcnt(4)
  v_pk_min_u16 v168, v162, v163
  v_pk_max_u16 v169, v162, v163
  v_pk_sub_u16 v170, v169, v168
  v_pk_sub_i16 v171, s70, v170
  v_pk_sub_u16 v162, s71, v170
  v_pk_ashrrev_i16 v171, s72, v171
  v_bfi_b32 v168, v171, v169, v168
  v_bfi_b32 v170, v171, v162, v170
  v_and_b32 v169, s73, v168
  v_pk_add_u16 v170, v170, v169
  v_lshlrev_b32_sdwa v63, 9, v168 dst_sel:DWORD dst_unused:UNUSED_PAD src0_sel:DWORD src1_sel:WORD_0
  v_lshlrev_b32_sdwa v69, 9, v168 dst_sel:DWORD dst_unused:UNUSED_PAD src0_sel:DWORD src1_sel:WORD_1
  v_add_u32_sdwa v63, v63, v170 dst_sel:DWORD dst_unused:UNUSED_PAD src0_sel:DWORD src1_sel:WORD_0
  v_add_u32_sdwa v69, v69, v170 dst_sel:DWORD dst_unused:UNUSED_PAD src0_sel:DWORD src1_sel:WORD_1
  v_lshrrev_b32 v111, 4, v170
  v_lshrrev_b32 v117, 20, v170
  v_and_or_b32 v111, v111, 28, v45
  v_and_or_b32 v117, v117, 28, v45
  s_waitcnt lgkmcnt(2)
  v_pk_min_u16 v168, v164, v165
  v_pk_max_u16 v169, v164, v165
  v_pk_sub_u16 v170, v169, v168
  v_pk_sub_i16 v171, s70, v170
  v_pk_sub_u16 v164, s71, v170
  v_pk_ashrrev_i16 v171, s72, v171
  v_bfi_b32 v168, v171, v169, v168
  v_bfi_b32 v170, v171, v164, v170
  v_and_b32 v169, s73, v168
  v_pk_add_u16 v170, v170, v169
  v_lshlrev_b32_sdwa v64, 9, v168 dst_sel:DWORD dst_unused:UNUSED_PAD src0_sel:DWORD src1_sel:WORD_0
  v_lshlrev_b32_sdwa v70, 9, v168 dst_sel:DWORD dst_unused:UNUSED_PAD src0_sel:DWORD src1_sel:WORD_1
  v_add_u32_sdwa v64, v64, v170 dst_sel:DWORD dst_unused:UNUSED_PAD src0_sel:DWORD src1_sel:WORD_0
  v_add_u32_sdwa v70, v70, v170 dst_sel:DWORD dst_unused:UNUSED_PAD src0_sel:DWORD src1_sel:WORD_1
  v_lshrrev_b32 v112, 4, v170
  v_lshrrev_b32 v118, 20, v170
  v_and_or_b32 v112, v112, 28, v45
  v_and_or_b32 v118, v118, 28, v45
  s_waitcnt lgkmcnt(0)
  v_pk_min_u16 v168, v166, v167
  v_pk_max_u16 v169, v166, v167
  v_pk_sub_u16 v170, v169, v168
  v_pk_sub_i16 v171, s70, v170
  v_pk_sub_u16 v166, s71, v170
  v_pk_ashrrev_i16 v171, s72, v171
  v_bfi_b32 v168, v171, v169, v168
  v_bfi_b32 v170, v171, v166, v170
  v_and_b32 v169, s73, v168
  v_pk_add_u16 v170, v170, v169
  v_lshlrev_b32_sdwa v65, 9, v168 dst_sel:DWORD dst_unused:UNUSED_PAD src0_sel:DWORD src1_sel:WORD_0
  v_lshlrev_b32_sdwa v71, 9, v168 dst_sel:DWORD dst_unused:UNUSED_PAD src0_sel:DWORD src1_sel:WORD_1
  v_add_u32_sdwa v65, v65, v170 dst_sel:DWORD dst_unused:UNUSED_PAD src0_sel:DWORD src1_sel:WORD_0
  v_add_u32_sdwa v71, v71, v170 dst_sel:DWORD dst_unused:UNUSED_PAD src0_sel:DWORD src1_sel:WORD_1
  v_lshrrev_b32 v113, 4, v170
  v_lshrrev_b32 v119, 20, v170
  v_and_or_b32 v113, v113, 28, v45
  v_and_or_b32 v119, v119, 28, v45
  s_setprio 0
  s_mov_b32 s79, 0
L_spinWL2_9:
  ds_read_b32 v173, v41 offset:40
  s_waitcnt lgkmcnt(0)
  v_readfirstlane_b32 s60, v173
  s_add_u32 s79, s79, 1
  s_cmp_ge_u32 s60, 4
  s_cbranch_scc1 L_spinxWL2_10
  s_cmp_gt_u32 s79, 0x100000
  s_cbranch_scc1 L_spinxWL2_10
  s_sleep 2
  s_branch L_spinWL2_9
L_spinxWL2_10:
  ds_read_b128 v[144:147], v192 offset:0
  ds_read_b128 v[148:151], v193 offset:0
  ds_read_b128 v[152:155], v194 offset:0
  ds_read_b128 v[156:159], v195 offset:0
  ds_read_b128 v[160:163], v192 offset:4096
  ds_read_b128 v[164:167], v193 offset:4096
  ds_read_b128 v[168:171], v194 offset:4096
  ds_read_b128 v[172:175], v195 offset:4096
  ds_read_b128 v[176:179], v196 offset:0
  ds_read_b128 v[180:183], v196 offset:64
  ds_read_b128 v[184:187], v196 offset:128
  ds_read_b128 v[188:191], v196 offset:192
  s_nop 1
  v_add_f32_dpp v124, v124, v124 row_shr:1 row_mask:0xf bank_mask:0xf
  s_nop 1
  v_add_f32_dpp v124, v124, v124 row_shr:2 row_mask:0xf bank_mask:0xf
  s_nop 1
  v_add_f32_dpp v124, v124, v124 row_shr:4 row_mask:0xf bank_mask:0xf
  s_nop 1
  v_add_f32_dpp v124, v124, v124 row_shr:8 row_mask:0xf bank_mask:0xf
  s_nop 1
  v_add_f32_dpp v124, v124, v124 row_bcast:15 row_mask:0xa bank_mask:0xf
  s_nop 1
  v_add_f32_dpp v124, v124, v124 row_bcast:31 row_mask:0xc bank_mask:0xf
  s_waitcnt lgkmcnt(0)
  s_setprio 3
  v_mfma_f32_16x16x32_bf16 v[200:203], v[144:147], v[176:179], 0
  v_mfma_f32_16x16x32_bf16 v[200:203], v[148:151], v[180:183], v[200:203]
  v_mfma_f32_16x16x32_bf16 v[200:203], v[152:155], v[184:187], v[200:203]
  v_mfma_f32_16x16x32_bf16 v[200:203], v[156:159], v[188:191], v[200:203]
  v_mfma_f32_16x16x32_bf16 v[204:207], v[160:163], v[176:179], 0
  v_mfma_f32_16x16x32_bf16 v[204:207], v[164:167], v[180:183], v[204:207]
  v_mfma_f32_16x16x32_bf16 v[204:207], v[168:171], v[184:187], v[204:207]
  v_mfma_f32_16x16x32_bf16 v[204:207], v[172:175], v[188:191], v[204:207]
  s_setprio 0
  v_readlane_b32 s68, v124, 63
  s_nop 1
  v_mov_b32 v120, s68
  v_mul_f32 v120, s69, v120
  s_nop 0
  v_readfirstlane_b32 s68, v120
  s_mov_b64 exec, 1
  ds_write_b32 v41, v120 offset:32
  s_mov_b64 exec, -1
  ds_write_b128 v199, v[200:203]
  ds_write_b128 v199, v[204:207] offset:64
  s_mov_b64 exec, 1
  ds_add_u32 v41, v44 offset:60
  s_mov_b64 exec, -1
  v_mov_b32 v132, 0
  v_mov_b32 v133, 0
  v_mov_b32 v134, 0
  v_mov_b32 v135, 0
  v_lshlrev_b32 v136, 4, v223
  buffer_load_dword v34, v220, s[64:67], 0 offen
  buffer_store_dwordx4 v[132:135], v136, s[36:39], s55 offen sc1
  buffer_store_dwordx4 v[132:135], v136, s[36:39], s55 offen offset:1024 sc1
  s_setprio 0
  ds_read_b32 v35, v214
  s_waitcnt vmcnt(2)
  s_mov_b64 exec, 1
  ds_add_u32 v41, v44 offset:52
  s_mov_b64 exec, -1
  s_mov_b64 exec, 1
  ds_add_u32 v41, v44 offset:56
  s_mov_b64 exec, -1
  s_mov_b32 s79, 0
L_spinWH_11:
  ds_read_b32 v173, v41 offset:60
  s_waitcnt lgkmcnt(0)
  v_readfirstlane_b32 s60, v173
  s_add_u32 s79, s79, 1
  s_cmp_ge_u32 s60, 4
  s_cbranch_scc1 L_spinxWH_12
  s_cmp_gt_u32 s79, 0x100000
  s_cbranch_scc1 L_spinxWH_12
  s_sleep 2
  s_branch L_spinWH_11
L_spinxWH_12:
  ds_read_b64 v[146:147], v215
  s_waitcnt lgkmcnt(0)
  v_lshlrev_b32 v148, 16, v35
  v_and_b32 v149, 0xffff0000, v35
  v_lshlrev_b32 v150, 16, v34
  v_and_b32 v151, 0xffff0000, v34
  v_mul_f32 v150, v150, v148
  v_mul_f32 v151, v151, v149
  v_mul_f32 v146, v146, v148
  v_mul_f32 v147, v147, v149
  v_cvt_pk_bf16_f32 v150, v150, v151
  v_cvt_pk_bf16_f32 v146, v146, v147
  s_mov_b32 s79, 0
L_spinW_13:
  ds_read_b32 v173, v41 offset:28
  s_waitcnt lgkmcnt(0)
  v_readfirstlane_b32 s60, v173
  s_add_u32 s79, s79, 1
  s_cmp_ge_u32 s60, 4
  s_cbranch_scc1 L_spinxW_14
  s_cmp_gt_u32 s79, 0x100000
  s_cbranch_scc1 L_spinxW_14
  s_sleep 2
  s_branch L_spinW_13
L_spinxW_14:
  ds_write_b32 v217, v146
  ds_write_b32 v217, v150 offset:272
  s_mov_b64 exec, 1
  ds_add_u32 v41, v44 offset:16
  s_mov_b64 exec, -1
  s_mov_b32 s79, 0
L_spinT3_15:
  ds_read_b32 v173, v41 offset:56
  s_waitcnt lgkmcnt(0)
  v_readfirstlane_b32 s60, v173
  s_add_u32 s79, s79, 1
  s_cmp_ge_u32 s60, 4
  s_cbranch_scc1 L_spinxT3_16
  s_cmp_gt_u32 s79, 0x100000
  s_cbranch_scc1 L_spinxT3_16
  s_sleep 2
  s_branch L_spinT3_15
L_spinxT3_16:
  ds_read_b128 v[120:123], v208 offset:0
  ds_read_b128 v[124:127], v209 offset:0
  ds_read_b128 v[128:131], v210 offset:0
  ds_read_b128 v[132:135], v211 offset:0
  ds_read_b128 v[136:139], v208 offset:4096
  ds_read_b128 v[140:143], v209 offset:4096
  ds_read_b128 v[144:147], v210 offset:4096
  ds_read_b128 v[148:151], v211 offset:4096
  ds_read_b128 v[152:155], v208 offset:8192
  ds_read_b128 v[156:159], v209 offset:8192
  ds_read_b128 v[160:163], v210 offset:8192
  ds_read_b128 v[164:167], v211 offset:8192
  s_waitcnt lgkmcnt(4)
  ds_read_b128 a[0:3], v208 offset:12288
  ds_read_b128 a[4:7], v209 offset:12288
  ds_read_b128 a[8:11], v210 offset:12288
  ds_read_b128 a[12:15], v211 offset:12288
  ds_read_b128 a[16:19], v208 offset:16384
  ds_read_b128 a[20:23], v209 offset:16384
  ds_read_b128 a[24:27], v210 offset:16384
  ds_read_b128 a[28:31], v211 offset:16384
  s_waitcnt lgkmcnt(4)
  ds_read_b128 v[0:3], v208 offset:20480
  ds_read_b128 v[4:7], v209 offset:20480
  ds_read_b128 v[8:11], v210 offset:20480
  ds_read_b128 v[12:15], v211 offset:20480
  ds_read_b128 v[16:19], v208 offset:24576
  ds_read_b128 v[20:23], v209 offset:24576
  ds_read_b128 v[24:27], v210 offset:24576
  ds_read_b128 v[28:31], v211 offset:24576
  s_waitcnt lgkmcnt(4)
  ds_read_b128 v[192:195], v208 offset:28672
  ds_read_b128 v[196:199], v209 offset:28672
  ds_read_b128 v[200:203], v210 offset:28672
  ds_read_b128 v[204:207], v211 offset:28672
  s_mov_b32 s79, 0
L_spinA_17:
  ds_read_b32 v175, v41 offset:16
  s_waitcnt lgkmcnt(0)
  v_readfirstlane_b32 s60, v175
  s_add_u32 s79, s79, 1
  s_cmp_ge_u32 s60, 4
  s_cbranch_scc1 L_spinxA_18
  s_cmp_gt_u32 s79, 0x100000
  s_cbranch_scc1 L_spinxA_18
  s_sleep 2
  s_branch L_spinA_17
L_spinxA_18:
  ds_read_b128 v[176:179], v213 offset:0
  ds_read_b128 v[180:183], v213 offset:64
  ds_read_b128 v[184:187], v213 offset:128
  ds_read_b128 v[188:191], v213 offset:192
  s_waitcnt lgkmcnt(0)
  s_setprio 3
  v_mfma_f32_16x16x32_bf16 v[168:171], v[176:179], v[120:123], 0
  v_mfma_f32_16x16x32_bf16 v[168:171], v[180:183], v[124:127], v[168:171]
  v_mfma_f32_16x16x32_bf16 v[168:171], v[184:187], v[128:131], v[168:171]
  v_mfma_f32_16x16x32_bf16 v[168:171], v[188:191], v[132:135], v[168:171]
  v_mfma_f32_16x16x32_bf16 v[172:175], v[176:179], v[136:139], 0
  v_mfma_f32_16x16x32_bf16 v[172:175], v[180:183], v[140:143], v[172:175]
  v_mfma_f32_16x16x32_bf16 v[172:175], v[184:187], v[144:147], v[172:175]
  v_mfma_f32_16x16x32_bf16 v[172:175], v[188:191], v[148:151], v[172:175]
  v_mfma_f32_16x16x32_bf16 v[32:35], v[176:179], v[152:155], 0
  v_mfma_f32_16x16x32_bf16 v[32:35], v[180:183], v[156:159], v[32:35]
  v_mfma_f32_16x16x32_bf16 v[32:35], v[184:187], v[160:163], v[32:35]
  v_mfma_f32_16x16x32_bf16 v[32:35], v[188:191], v[164:167], v[32:35]
  v_mfma_f32_16x16x32_bf16 v[36:39], v[176:179], a[0:3], 0
  v_mfma_f32_16x16x32_bf16 v[36:39], v[180:183], a[4:7], v[36:39]
  v_mfma_f32_16x16x32_bf16 v[36:39], v[184:187], a[8:11], v[36:39]
  v_mfma_f32_16x16x32_bf16 v[36:39], v[188:191], a[12:15], v[36:39]
  v_mfma_f32_16x16x32_bf16 v[120:123], v[176:179], a[16:19], 0
  v_mfma_f32_16x16x32_bf16 v[120:123], v[180:183], a[20:23], v[120:123]
  v_mfma_f32_16x16x32_bf16 v[120:123], v[184:187], a[24:27], v[120:123]
  v_mfma_f32_16x16x32_bf16 v[120:123], v[188:191], a[28:31], v[120:123]
  v_mfma_f32_16x16x32_bf16 v[124:127], v[176:179], v[0:3], 0
  v_mfma_f32_16x16x32_bf16 v[124:127], v[180:183], v[4:7], v[124:127]
  v_mfma_f32_16x16x32_bf16 v[124:127], v[184:187], v[8:11], v[124:127]
  v_mfma_f32_16x16x32_bf16 v[124:127], v[188:191], v[12:15], v[124:127]
  v_mfma_f32_16x16x32_bf16 v[128:131], v[176:179], v[16:19], 0
  v_mfma_f32_16x16x32_bf16 v[128:131], v[180:183], v[20:23], v[128:131]
  v_mfma_f32_16x16x32_bf16 v[128:131], v[184:187], v[24:27], v[128:131]
  v_mfma_f32_16x16x32_bf16 v[128:131], v[188:191], v[28:31], v[128:131]
  v_mfma_f32_16x16x32_bf16 v[132:135], v[176:179], v[192:195], 0
  v_mfma_f32_16x16x32_bf16 v[132:135], v[180:183], v[196:199], v[132:135]
  v_mfma_f32_16x16x32_bf16 v[132:135], v[184:187], v[200:203], v[132:135]
  v_mfma_f32_16x16x32_bf16 v[132:135], v[188:191], v[204:207], v[132:135]
  s_setprio 0
  ds_write_b64 v212, v[168:169] offset:0
  ds_write_b64 v212, v[170:171] offset:4096
  ds_write_b64 v212, v[172:173] offset:128
  ds_write_b64 v212, v[174:175] offset:4224
  ds_write_b64 v212, v[32:33] offset:256
  ds_write_b64 v212, v[34:35] offset:4352
  ds_write_b64 v212, v[36:37] offset:384
  ds_write_b64 v212, v[38:39] offset:4480
  s_waitcnt lgkmcnt(4)
  ds_write_b64 v212, v[120:121] offset:512
  ds_write_b64 v212, v[122:123] offset:4608
  ds_write_b64 v212, v[124:125] offset:640
  ds_write_b64 v212, v[126:127] offset:4736
  s_nop 3
  ds_write_b64 v212, v[128:129] offset:768
  ds_write_b64 v212, v[130:131] offset:4864
  ds_write_b64 v212, v[132:133] offset:896
  ds_write_b64 v212, v[134:135] offset:4992
  s_mov_b64 exec, 1
  ds_add_u32 v41, v44 offset:20
  s_mov_b64 exec, -1
  s_setprio 0
  s_lshr_b32 s59, s2, 3
  s_and_b32 s59, s59, 31
  s_lshl_b32 s59, s59, 5
  v_lshrrev_b32 v217, 1, v223
  v_add_u32 v217, s59, v217
  v_lshlrev_b32 v217, 9, v217
  v_and_b32 v144, 1, v223
  v_lshl_add_u32 v217, v144, 5, v217
  s_waitcnt vmcnt(0)
  s_mov_b64 exec, 1
  ds_add_u32 v41, v44 offset:36
  s_mov_b64 exec, -1
  s_mov_b32 s79, 0
L_spinC_19:
  ds_read_b32 v173, v41 offset:20
  s_waitcnt lgkmcnt(0)
  v_readfirstlane_b32 s60, v173
  s_add_u32 s79, s79, 1
  s_cmp_ge_u32 s60, 4
  s_cbranch_scc1 L_spinxC_20
  s_cmp_gt_u32 s79, 0x100000
  s_cbranch_scc1 L_spinxC_20
  s_sleep 2
  s_branch L_spinC_19
L_spinxC_20:
  s_cmp_lg_u32 s26, 0
  s_cbranch_scc1 L_nopost
  s_mov_b32 s79, 0
L_spinZ_21:
  ds_read_b32 v173, v41 offset:36
  s_waitcnt lgkmcnt(0)
  v_readfirstlane_b32 s60, v173
  s_add_u32 s79, s79, 1
  s_cmp_ge_u32 s60, 4
  s_cbranch_scc1 L_spinxZ_22
  s_cmp_gt_u32 s79, 0x100000
  s_cbranch_scc1 L_spinxZ_22
  s_sleep 2
  s_branch L_spinZ_21
L_spinxZ_22:
  s_and_b32 s59, s2, 63
  s_lshl_b32 s59, s59, 2
  v_mov_b32 v154, s59
  s_mov_b64 exec, 1
  global_atomic_add v154, v44, s[22:23] sc1
  s_mov_b64 exec, -1
L_nopost:
  s_mov_b32 s79, 0
L_spinE0_23:
  ds_read_b32 v173, v42 offset:0
  s_waitcnt lgkmcnt(0)
  v_readfirstlane_b32 s60, v173
  s_add_u32 s79, s79, 1
  s_cmp_ge_u32 s60, 1
  s_cbranch_scc1 L_spinxE0_24
  s_cmp_gt_u32 s79, 0x100000
  s_cbranch_scc1 L_spinxE0_24
  s_sleep 2
  s_branch L_spinE0_23
L_spinxE0_24:
  ds_read_b32 v168, v43 offset:0
  ds_read_b64 v[170:171], v216 offset:0
  v_mov_b32 v169, s68
  s_waitcnt lgkmcnt(0)
  v_add_f32 v168, v168, v170
  v_fma_f32 v168, v168, s69, v169
  v_cvt_pk_bf16_f32 v168, v168, v171
  v_max_u32 v168, 1, v168
  buffer_store_dword v168, v47, s[36:39], 0 offen offset:0 sc1
  v_lshlrev_b32 v144, 3, v223
  v_add_u32 v144, s74, v144
  v_mov_b32 v146, 0
  v_mov_b32 v147, 0
  ds_write_b64 v144, v[146:147]
  ds_add_rtn_u32 v120, v96, v44 offset:0
  ds_add_rtn_u32 v121, v97, v44 offset:0
  ds_add_rtn_u32 v122, v98, v44 offset:0
  ds_add_rtn_u32 v123, v99, v44 offset:0
  s_mov_b32 exec_hi, 7
  ds_add_rtn_u32 v124, v100, v44 offset:0
  s_mov_b32 exec_hi, -1
  s_mov_b32 exec_hi, 3
  ds_add_rtn_u32 v125, v101, v44 offset:0
  s_mov_b32 exec_hi, -1
  s_waitcnt lgkmcnt(8)
  ds_add_rtn_u32 v126, v102, v44 offset:128
  ds_add_rtn_u32 v127, v103, v44 offset:128
  ds_add_rtn_u32 v128, v104, v44 offset:128
  ds_add_rtn_u32 v129, v105, v44 offset:128
  s_mov_b32 exec_hi, 7
  ds_add_rtn_u32 v130, v106, v44 offset:128
  s_mov_b32 exec_hi, -1
  s_mov_b32 exec_hi, 3
  ds_add_rtn_u32 v131, v107, v44 offset:128
  s_mov_b32 exec_hi, -1
  s_waitcnt lgkmcnt(8)
  ds_add_rtn_u32 v132, v108, v44 offset:256
  ds_add_rtn_u32 v133, v109, v44 offset:256
  ds_add_rtn_u32 v134, v110, v44 offset:256
  ds_add_rtn_u32 v135, v111, v44 offset:256
  s_mov_b32 exec_hi, 7
  ds_add_rtn_u32 v136, v112, v44 offset:256
  s_mov_b32 exec_hi, -1
  s_mov_b32 exec_hi, 3
  ds_add_rtn_u32 v137, v113, v44 offset:256
  s_mov_b32 exec_hi, -1
  s_waitcnt lgkmcnt(8)
  ds_add_rtn_u32 v138, v114, v44 offset:384
  ds_add_rtn_u32 v139, v115, v44 offset:384
  ds_add_rtn_u32 v140, v116, v44 offset:384
  ds_add_rtn_u32 v141, v117, v44 offset:384
  s_mov_b32 exec_hi, 7
  ds_add_rtn_u32 v142, v118, v44 offset:384
  s_mov_b32 exec_hi, -1
  s_mov_b32 exec_hi, 3
  ds_add_rtn_u32 v143, v119, v44 offset:384
  s_mov_b32 exec_hi, -1
  s_waitcnt lgkmcnt(8)
  v_and_b32 v145, 3, v223
  v_lshlrev_b32 v145, 5, v145
  v_bfe_u32 v146, v223, 2, 3
  v_lshl_add_u32 v145, v146, 2, v145
  v_lshrrev_b32 v146, 5, v223
  v_lshl_add_u32 v145, v146, 7, v145
  v_add_u32 v145, s74, v145
  ds_read_b32 v148, v145
  ds_read_b32 v149, v145 offset:256
  v_and_b32 v146, 7, v223
  v_bfe_u32 v147, v223, 3, 2
  v_lshl_add_u32 v146, v146, 2, v147
  v_and_b32 v147, 32, v223
  v_add_lshl_u32 v146, v146, v147, 2
  s_waitcnt lgkmcnt(0)
  v_mov_b32 v150, v148
  v_mov_b32 v151, v149
  s_nop 0
  v_add_u32_dpp v148, v148, v148 row_shr:1 row_mask:0xf bank_mask:0xf
  v_add_u32_dpp v149, v149, v149 row_shr:1 row_mask:0xf bank_mask:0xf
  s_nop 0
  v_add_u32_dpp v148, v148, v148 row_shr:2 row_mask:0xf bank_mask:0xf
  v_add_u32_dpp v149, v149, v149 row_shr:2 row_mask:0xf bank_mask:0xf
  s_nop 0
  v_add_u32_dpp v148, v148, v148 row_shr:4 row_mask:0xf bank_mask:0xf
  v_add_u32_dpp v149, v149, v149 row_shr:4 row_mask:0xf bank_mask:0xf
  s_nop 0
  v_add_u32_dpp v148, v148, v148 row_shr:8 row_mask:0xf bank_mask:0xf
  v_add_u32_dpp v149, v149, v149 row_shr:8 row_mask:0xf bank_mask:0xf
  s_nop 0
  v_add_u32_dpp v148, v148, v148 row_bcast:15 row_mask:0xa bank_mask:0xf
  v_add_u32_dpp v149, v149, v149 row_bcast:15 row_mask:0xa bank_mask:0xf
  v_sub_u32 v148, v148, v150
  v_sub_u32 v149, v149, v151
  v_add_u32 v148, s75, v148
  v_add_u32 v149, s75, v149
  ds_bpermute_b32 v40, v146, v148
  ds_bpermute_b32 v39, v146, v149
  s_waitcnt lgkmcnt(0)
  s_mov_b32 s79, 0
L_spinE1_25:
  ds_read_b32 v173, v42 offset:0
  s_waitcnt lgkmcnt(0)
  v_readfirstlane_b32 s60, v173
  s_add_u32 s79, s79, 1
  s_cmp_ge_u32 s60, 2
  s_cbranch_scc1 L_spinxE1_26
  s_cmp_gt_u32 s79, 0x100000
  s_cbranch_scc1 L_spinxE1_26
  s_sleep 2
  s_branch L_spinE1_25
L_spinxE1_26:
  ds_read_b32 v168, v43 offset:1024
  ds_read_b64 v[170:171], v216 offset:512
  v_mov_b32 v169, s68
  s_waitcnt lgkmcnt(0)
  v_add_f32 v168, v168, v170
  v_fma_f32 v168, v168, s69, v169
  v_cvt_pk_bf16_f32 v168, v168, v171
  v_max_u32 v168, 1, v168
  buffer_store_dword v168, v47, s[36:39], 0 offen offset:256 sc1
  global_load_dword v175, v220, s[22:23] sc1
  ds_bpermute_b32 v144, v96, v40 offset:0
  ds_bpermute_b32 v145, v97, v40 offset:0
  ds_bpermute_b32 v146, v98, v40 offset:0
  ds_bpermute_b32 v147, v99, v40 offset:0
  ds_bpermute_b32 v148, v100, v40 offset:0
  ds_bpermute_b32 v149, v101, v40 offset:0
  ds_bpermute_b32 v150, v102, v40 offset:128
  ds_bpermute_b32 v151, v103, v40 offset:128
  ds_bpermute_b32 v152, v104, v40 offset:128
  ds_bpermute_b32 v153, v105, v40 offset:128
  ds_bpermute_b32 v154, v106, v40 offset:128
  ds_bpermute_b32 v155, v107, v40 offset:128
  s_waitcnt lgkmcnt(11)
  v_add_lshl_u32 v96, v144, v120, 2
  s_waitcnt lgkmcnt(10)
  v_add_lshl_u32 v97, v145, v121, 2
  s_waitcnt lgkmcnt(9)
  v_add_lshl_u32 v98, v146, v122, 2
  s_waitcnt lgkmcnt(8)
  v_add_lshl_u32 v99, v147, v123, 2
  s_waitcnt lgkmcnt(7)
  v_add_lshl_u32 v100, v148, v124, 2
  s_waitcnt lgkmcnt(6)
  v_add_lshl_u32 v101, v149, v125, 2
  s_waitcnt lgkmcnt(5)
  v_add_lshl_u32 v102, v150, v126, 2
  s_waitcnt lgkmcnt(4)
  v_add_lshl_u32 v103, v151, v127, 2
  s_waitcnt lgkmcnt(3)
  v_add_lshl_u32 v104, v152, v128, 2
  s_waitcnt lgkmcnt(2)
  v_add_lshl_u32 v105, v153, v129, 2
  s_waitcnt lgkmcnt(1)
  v_add_lshl_u32 v106, v154, v130, 2
  s_waitcnt lgkmcnt(0)
  v_add_lshl_u32 v107, v155, v131, 2
  ds_bpermute_b32 v144, v108, v39 offset:0
  ds_bpermute_b32 v145, v109, v39 offset:0
  ds_bpermute_b32 v146, v110, v39 offset:0
  ds_bpermute_b32 v147, v111, v39 offset:0
  ds_bpermute_b32 v148, v112, v39 offset:0
  ds_bpermute_b32 v149, v113, v39 offset:0
  ds_bpermute_b32 v150, v114, v39 offset:128
  ds_bpermute_b32 v151, v115, v39 offset:128
  ds_bpermute_b32 v152, v116, v39 offset:128
  ds_bpermute_b32 v153, v117, v39 offset:128
  ds_bpermute_b32 v154, v118, v39 offset:128
  ds_bpermute_b32 v155, v119, v39 offset:128
  s_waitcnt lgkmcnt(11)
  v_add_lshl_u32 v108, v144, v132, 2
  s_waitcnt lgkmcnt(10)
  v_add_lshl_u32 v109, v145, v133, 2
  s_waitcnt lgkmcnt(9)
  v_add_lshl_u32 v110, v146, v134, 2
  s_waitcnt lgkmcnt(8)
  v_add_lshl_u32 v111, v147, v135, 2
  s_waitcnt lgkmcnt(7)
  v_add_lshl_u32 v112, v148, v136, 2
  s_waitcnt lgkmcnt(6)
  v_add_lshl_u32 v113, v149, v137, 2
  s_waitcnt lgkmcnt(5)
  v_add_lshl_u32 v114, v150, v138, 2
  s_waitcnt lgkmcnt(4)
  v_add_lshl_u32 v115, v151, v139, 2
  s_waitcnt lgkmcnt(3)
  v_add_lshl_u32 v116, v152, v140, 2
  s_waitcnt lgkmcnt(2)
  v_add_lshl_u32 v117, v153, v141, 2
  s_waitcnt lgkmcnt(1)
  v_add_lshl_u32 v118, v154, v142, 2
  s_waitcnt lgkmcnt(0)
  v_add_lshl_u32 v119, v155, v143, 2
  ds_write_b32 v96, v48
  ds_write_b32 v97, v49
  ds_write_b32 v98, v50
  ds_write_b32 v99, v51
  s_mov_b32 exec_hi, 7
  ds_write_b32 v100, v52
  s_mov_b32 exec_hi, -1
  s_mov_b32 exec_hi, 3
  ds_write_b32 v101, v53
  s_mov_b32 exec_hi, -1
  s_waitcnt lgkmcnt(8)
  ds_read_b32 v48, v46 offset:0
  ds_read_b32 v49, v46 offset:256
  ds_read_b32 v50, v46 offset:512
  ds_read_b32 v51, v46 offset:768
  ds_read_b32 v52, v46 offset:1024
  ds_read_b32 v53, v46 offset:1280
  ds_write_b32 v102, v54
  ds_write_b32 v103, v55
  ds_write_b32 v104, v56
  ds_write_b32 v105, v57
  s_mov_b32 exec_hi, 7
  ds_write_b32 v106, v58
  s_mov_b32 exec_hi, -1
  s_mov_b32 exec_hi, 3
  ds_write_b32 v107, v59
  s_mov_b32 exec_hi, -1
  s_waitcnt lgkmcnt(8)
  ds_read_b32 v54, v46 offset:0
  ds_read_b32 v55, v46 offset:256
  ds_read_b32 v56, v46 offset:512
  ds_read_b32 v57, v46 offset:768
  ds_read_b32 v58, v46 offset:1024
  ds_read_b32 v59, v46 offset:1280
  ds_write_b32 v108, v60
  ds_write_b32 v109, v61
  ds_write_b32 v110, v62
  ds_write_b32 v111, v63
  s_mov_b32 exec_hi, 7
  ds_write_b32 v112, v64
  s_mov_b32 exec_hi, -1
  s_mov_b32 exec_hi, 3
  ds_write_b32 v113, v65
  s_mov_b32 exec_hi, -1
  s_waitcnt lgkmcnt(8)
  ds_read_b32 v60, v46 offset:0
  ds_read_b32 v61, v46 offset:256
  ds_read_b32 v62, v46 offset:512
  ds_read_b32 v63, v46 offset:768
  ds_read_b32 v64, v46 offset:1024
  ds_read_b32 v65, v46 offset:1280
  ds_write_b32 v114, v66
  ds_write_b32 v115, v67
  ds_write_b32 v116, v68
  ds_write_b32 v117, v69
  s_mov_b32 exec_hi, 7
  ds_write_b32 v118, v70
  s_mov_b32 exec_hi, -1
  s_mov_b32 exec_hi, 3
  ds_write_b32 v119, v71
  s_mov_b32 exec_hi, -1
  s_waitcnt lgkmcnt(8)
  ds_read_b32 v66, v46 offset:0
  ds_read_b32 v67, v46 offset:256
  ds_read_b32 v68, v46 offset:512
  ds_read_b32 v69, v46 offset:768
  ds_read_b32 v70, v46 offset:1024
  ds_read_b32 v71, v46 offset:1280
  s_waitcnt lgkmcnt(0)
  s_mov_b32 s79, 0
L_spinE2_27:
  ds_read_b32 v173, v42 offset:0
  s_waitcnt lgkmcnt(0)
  v_readfirstlane_b32 s60, v173
  s_add_u32 s79, s79, 1
  s_cmp_ge_u32 s60, 3
  s_cbranch_scc1 L_spinxE2_28
  s_cmp_gt_u32 s79, 0x100000
  s_cbranch_scc1 L_spinxE2_28
  s_sleep 2
  s_branch L_spinE2_27
L_spinxE2_28:
  ds_read_b32 v168, v43 offset:2048
  ds_read_b64 v[170:171], v216 offset:1024
  v_mov_b32 v169, s68
  s_waitcnt lgkmcnt(0)
  v_add_f32 v168, v168, v170
  v_fma_f32 v168, v168, s69, v169
  v_cvt_pk_bf16_f32 v168, v168, v171
  v_max_u32 v168, 1, v168
  buffer_store_dword v168, v47, s[36:39], 0 offen offset:512 sc1
  v_and_b32 v96, 511, v48
  v_and_b32 v97, 511, v49
  v_and_b32 v98, 511, v50
  v_and_b32 v99, 511, v51
  v_and_b32 v100, 511, v52
  v_and_b32 v101, 511, v53
  v_and_b32 v102, 511, v54
  v_and_b32 v103, 511, v55
  v_and_b32 v104, 511, v56
  v_and_b32 v105, 511, v57
  v_and_b32 v106, 511, v58
  v_and_b32 v107, 511, v59
  v_and_b32 v108, 511, v60
  v_and_b32 v109, 511, v61
  v_and_b32 v110, 511, v62
  v_and_b32 v111, 511, v63
  v_and_b32 v112, 511, v64
  v_and_b32 v113, 511, v65
  v_and_b32 v114, 511, v66
  v_and_b32 v115, 511, v67
  v_and_b32 v116, 511, v68
  v_and_b32 v117, 511, v69
  v_and_b32 v118, 511, v70
  v_and_b32 v119, 511, v71
  v_mov_b32 v145, 4
  v_cmp_le_u32 vcc, 58, v223
  s_waitcnt vmcnt(0)
  s_nop 0
  v_cndmask_b32 v145, v145, 3, vcc
  s_nop 0
  v_cmp_lt_u32 vcc, v175, v145
  s_cbranch_vccz L_zok_29
  v_mov_b32 v145, 4
  v_cmp_le_u32 vcc, 58, v223
  s_mov_b32 s79, 0
  s_nop 0
  v_cndmask_b32 v145, v145, 3, vcc
L_zc_30:
  global_load_dword v144, v220, s[22:23] sc1
  s_waitcnt vmcnt(0)
  v_cmp_lt_u32 vcc, v144, v145
  s_add_u32 s79, s79, 1
  s_cbranch_vccz L_zcx_31
  s_cmp_gt_u32 s79, 0x40000
  s_cbranch_scc1 L_zcx_31
  s_sleep 8
  s_branch L_zc_30
L_zcx_31:
L_zok_29:
  s_mov_b32 s79, 0
L_spinE3_32:
  ds_read_b32 v173, v42 offset:0
  s_waitcnt lgkmcnt(0)
  v_readfirstlane_b32 s60, v173
  s_add_u32 s79, s79, 1
  s_cmp_ge_u32 s60, 4
  s_cbranch_scc1 L_spinxE3_33
  s_cmp_gt_u32 s79, 0x100000
  s_cbranch_scc1 L_spinxE3_33
  s_sleep 2
  s_branch L_spinE3_32
L_spinxE3_33:
  ds_read_b32 v168, v43 offset:3072
  ds_read_b64 v[170:171], v216 offset:1536
  v_mov_b32 v169, s68
  s_waitcnt lgkmcnt(0)
  v_add_f32 v168, v168, v170
  v_fma_f32 v168, v168, s69, v169
  v_cvt_pk_bf16_f32 v168, v168, v171
  v_max_u32 v168, 1, v168
  buffer_store_dword v168, v47, s[36:39], 0 offen offset:768 sc1
  s_waitcnt vmcnt(1)
  s_movk_i32 s62, 192
  v_cmp_gt_u32 s[64:65], s62, v96
  v_cmp_eq_u32 vcc, 0, v72
  s_and_b64 vcc, vcc, s[64:65]
  s_cbranch_scc0 L_rd_35
  s_mov_b64 exec, vcc
  buffer_load_dword v72, v48, s[40:43], 0 idxen
  s_mov_b64 exec, -1
L_rd_35:
  v_cmp_gt_u32 s[64:65], s62, v102
  v_cmp_eq_u32 vcc, 0, v78
  s_and_b64 vcc, vcc, s[64:65]
  s_cbranch_scc0 L_rd_36
  s_mov_b64 exec, vcc
  buffer_load_dword v78, v54, s[40:43], 0 idxen
  s_mov_b64 exec, -1
L_rd_36:
  v_cmp_gt_u32 s[64:65], s62, v108
  v_cmp_eq_u32 vcc, 0, v84
  s_and_b64 vcc, vcc, s[64:65]
  s_cbranch_scc0 L_rd_37
  s_mov_b64 exec, vcc
  buffer_load_dword v84, v60, s[40:43], 0 idxen
  s_mov_b64 exec, -1
L_rd_37:
  v_cmp_gt_u32 s[64:65], s62, v114
  v_cmp_eq_u32 vcc, 0, v90
  s_and_b64 vcc, vcc, s[64:65]
  s_cbranch_scc0 L_rd_38
  s_mov_b64 exec, vcc
  buffer_load_dword v90, v66, s[40:43], 0 idxen
  s_mov_b64 exec, -1
L_rd_38:
  v_cmp_gt_u32 s[64:65], s62, v97
  v_cmp_eq_u32 vcc, 0, v73
  s_and_b64 vcc, vcc, s[64:65]
  s_cbranch_scc0 L_rd_39
  s_mov_b64 exec, vcc
  buffer_load_dword v73, v49, s[40:43], 0 idxen
  s_mov_b64 exec, -1
L_rd_39:
  v_cmp_gt_u32 s[64:65], s62, v103
  v_cmp_eq_u32 vcc, 0, v79
  s_and_b64 vcc, vcc, s[64:65]
  s_cbranch_scc0 L_rd_40
  s_mov_b64 exec, vcc
  buffer_load_dword v79, v55, s[40:43], 0 idxen
  s_mov_b64 exec, -1
L_rd_40:
  v_cmp_gt_u32 s[64:65], s62, v109
  v_cmp_eq_u32 vcc, 0, v85
  s_and_b64 vcc, vcc, s[64:65]
  s_cbranch_scc0 L_rd_41
  s_mov_b64 exec, vcc
  buffer_load_dword v85, v61, s[40:43], 0 idxen
  s_mov_b64 exec, -1
L_rd_41:
  v_cmp_gt_u32 s[64:65], s62, v115
  v_cmp_eq_u32 vcc, 0, v91
  s_and_b64 vcc, vcc, s[64:65]
  s_cbranch_scc0 L_rd_42
  s_mov_b64 exec, vcc
  buffer_load_dword v91, v67, s[40:43], 0 idxen
  s_mov_b64 exec, -1
L_rd_42:
L_skipr_34:
  s_mov_b32 s79, 0
L_spinE4_43:
  ds_read_b32 v173, v42 offset:0
  s_waitcnt lgkmcnt(0)
  v_readfirstlane_b32 s60, v173
  s_add_u32 s79, s79, 1
  s_cmp_ge_u32 s60, 5
  s_cbranch_scc1 L_spinxE4_44
  s_cmp_gt_u32 s79, 0x100000
  s_cbranch_scc1 L_spinxE4_44
  s_sleep 2
  s_branch L_spinE4_43
L_spinxE4_44:
  ds_read_b32 v168, v43 offset:4096
  ds_read_b64 v[170:171], v216 offset:2048
  v_mov_b32 v169, s68
  s_waitcnt lgkmcnt(0)
  v_add_f32 v168, v168, v170
  v_fma_f32 v168, v168, s69, v169
  v_cvt_pk_bf16_f32 v168, v168, v171
  v_max_u32 v168, 1, v168
  buffer_store_dword v168, v47, s[36:39], 0 offen offset:1024 sc1
  s_waitcnt vmcnt(1)
  s_movk_i32 s62, 256
  v_cmp_gt_u32 s[64:65], s62, v97
  v_cmp_eq_u32 vcc, 0, v73
  s_and_b64 vcc, vcc, s[64:65]
  s_cbranch_scc0 L_rd_46
  s_mov_b64 exec, vcc
  buffer_load_dword v73, v49, s[40:43], 0 idxen
  s_mov_b64 exec, -1
L_rd_46:
  v_cmp_gt_u32 s[64:65], s62, v103
  v_cmp_eq_u32 vcc, 0, v79
  s_and_b64 vcc, vcc, s[64:65]
  s_cbranch_scc0 L_rd_47
  s_mov_b64 exec, vcc
  buffer_load_dword v79, v55, s[40:43], 0 idxen
  s_mov_b64 exec, -1
L_rd_47:
  v_cmp_gt_u32 s[64:65], s62, v109
  v_cmp_eq_u32 vcc, 0, v85
  s_and_b64 vcc, vcc, s[64:65]
  s_cbranch_scc0 L_rd_48
  s_mov_b64 exec, vcc
  buffer_load_dword v85, v61, s[40:43], 0 idxen
  s_mov_b64 exec, -1
L_rd_48:
  v_cmp_gt_u32 s[64:65], s62, v115
  v_cmp_eq_u32 vcc, 0, v91
  s_and_b64 vcc, vcc, s[64:65]
  s_cbranch_scc0 L_rd_49
  s_mov_b64 exec, vcc
  buffer_load_dword v91, v67, s[40:43], 0 idxen
  s_mov_b64 exec, -1
L_rd_49:
  v_cmp_gt_u32 s[64:65], s62, v98
  v_cmp_eq_u32 vcc, 0, v74
  s_and_b64 vcc, vcc, s[64:65]
  s_cbranch_scc0 L_rd_50
  s_mov_b64 exec, vcc
  buffer_load_dword v74, v50, s[40:43], 0 idxen
  s_mov_b64 exec, -1
L_rd_50:
  v_cmp_gt_u32 s[64:65], s62, v104
  v_cmp_eq_u32 vcc, 0, v80
  s_and_b64 vcc, vcc, s[64:65]
  s_cbranch_scc0 L_rd_51
  s_mov_b64 exec, vcc
  buffer_load_dword v80, v56, s[40:43], 0 idxen
  s_mov_b64 exec, -1
L_rd_51:
  v_cmp_gt_u32 s[64:65], s62, v110
  v_cmp_eq_u32 vcc, 0, v86
  s_and_b64 vcc, vcc, s[64:65]
  s_cbranch_scc0 L_rd_52
  s_mov_b64 exec, vcc
  buffer_load_dword v86, v62, s[40:43], 0 idxen
  s_mov_b64 exec, -1
L_rd_52:
  v_cmp_gt_u32 s[64:65], s62, v116
  v_cmp_eq_u32 vcc, 0, v92
  s_and_b64 vcc, vcc, s[64:65]
  s_cbranch_scc0 L_rd_53
  s_mov_b64 exec, vcc
  buffer_load_dword v92, v68, s[40:43], 0 idxen
  s_mov_b64 exec, -1
L_rd_53:
L_skipr_45:
  s_mov_b32 s79, 0
L_spinE5_54:
  ds_read_b32 v173, v42 offset:0
  s_waitcnt lgkmcnt(0)
  v_readfirstlane_b32 s60, v173
  s_add_u32 s79, s79, 1
  s_cmp_ge_u32 s60, 6
  s_cbranch_scc1 L_spinxE5_55
  s_cmp_gt_u32 s79, 0x100000
  s_cbranch_scc1 L_spinxE5_55
  s_sleep 2
  s_branch L_spinE5_54
L_spinxE5_55:
  ds_read_b32 v168, v43 offset:5120
  ds_read_b64 v[170:171], v216 offset:2560
  v_mov_b32 v169, s68
  s_waitcnt lgkmcnt(0)
  v_add_f32 v168, v168, v170
  v_fma_f32 v168, v168, s69, v169
  v_cvt_pk_bf16_f32 v168, v168, v171
  v_max_u32 v168, 1, v168
  buffer_store_dword v168, v47, s[36:39], 0 offen offset:1280 sc1
  s_waitcnt vmcnt(1)
  s_movk_i32 s62, 320
  v_cmp_gt_u32 s[64:65], s62, v98
  v_cmp_eq_u32 vcc, 0, v74
  s_and_b64 vcc, vcc, s[64:65]
  s_cbranch_scc0 L_rd_57
  s_mov_b64 exec, vcc
  buffer_load_dword v74, v50, s[40:43], 0 idxen
  s_mov_b64 exec, -1
L_rd_57:
  v_cmp_gt_u32 s[64:65], s62, v104
  v_cmp_eq_u32 vcc, 0, v80
  s_and_b64 vcc, vcc, s[64:65]
  s_cbranch_scc0 L_rd_58
  s_mov_b64 exec, vcc
  buffer_load_dword v80, v56, s[40:43], 0 idxen
  s_mov_b64 exec, -1
L_rd_58:
  v_cmp_gt_u32 s[64:65], s62, v110
  v_cmp_eq_u32 vcc, 0, v86
  s_and_b64 vcc, vcc, s[64:65]
  s_cbranch_scc0 L_rd_59
  s_mov_b64 exec, vcc
  buffer_load_dword v86, v62, s[40:43], 0 idxen
  s_mov_b64 exec, -1
L_rd_59:
  v_cmp_gt_u32 s[64:65], s62, v116
  v_cmp_eq_u32 vcc, 0, v92
  s_and_b64 vcc, vcc, s[64:65]
  s_cbranch_scc0 L_rd_60
  s_mov_b64 exec, vcc
  buffer_load_dword v92, v68, s[40:43], 0 idxen
  s_mov_b64 exec, -1
L_rd_60:
  v_cmp_gt_u32 s[64:65], s62, v99
  v_cmp_eq_u32 vcc, 0, v75
  s_and_b64 vcc, vcc, s[64:65]
  s_cbranch_scc0 L_rd_61
  s_mov_b64 exec, vcc
  buffer_load_dword v75, v51, s[40:43], 0 idxen
  s_mov_b64 exec, -1
L_rd_61:
  v_cmp_gt_u32 s[64:65], s62, v105
  v_cmp_eq_u32 vcc, 0, v81
  s_and_b64 vcc, vcc, s[64:65]
  s_cbranch_scc0 L_rd_62
  s_mov_b64 exec, vcc
  buffer_load_dword v81, v57, s[40:43], 0 idxen
  s_mov_b64 exec, -1
L_rd_62:
  v_cmp_gt_u32 s[64:65], s62, v111
  v_cmp_eq_u32 vcc, 0, v87
  s_and_b64 vcc, vcc, s[64:65]
  s_cbranch_scc0 L_rd_63
  s_mov_b64 exec, vcc
  buffer_load_dword v87, v63, s[40:43], 0 idxen
  s_mov_b64 exec, -1
L_rd_63:
  v_cmp_gt_u32 s[64:65], s62, v117
  v_cmp_eq_u32 vcc, 0, v93
  s_and_b64 vcc, vcc, s[64:65]
  s_cbranch_scc0 L_rd_64
  s_mov_b64 exec, vcc
  buffer_load_dword v93, v69, s[40:43], 0 idxen
  s_mov_b64 exec, -1
L_rd_64:
L_skipr_56:
  s_mov_b32 s79, 0
L_spinE6_65:
  ds_read_b32 v173, v42 offset:0
  s_waitcnt lgkmcnt(0)
  v_readfirstlane_b32 s60, v173
  s_add_u32 s79, s79, 1
  s_cmp_ge_u32 s60, 7
  s_cbranch_scc1 L_spinxE6_66
  s_cmp_gt_u32 s79, 0x100000
  s_cbranch_scc1 L_spinxE6_66
  s_sleep 2
  s_branch L_spinE6_65
L_spinxE6_66:
  ds_read_b32 v168, v43 offset:6144
  ds_read_b64 v[170:171], v216 offset:3072
  v_mov_b32 v169, s68
  s_waitcnt lgkmcnt(0)
  v_add_f32 v168, v168, v170
  v_fma_f32 v168, v168, s69, v169
  v_cvt_pk_bf16_f32 v168, v168, v171
  v_max_u32 v168, 1, v168
  buffer_store_dword v168, v47, s[36:39], 0 offen offset:1536 sc1
  s_waitcnt vmcnt(1)
  s_movk_i32 s62, 384
  v_cmp_gt_u32 s[64:65], s62, v99
  v_cmp_eq_u32 vcc, 0, v75
  s_and_b64 vcc, vcc, s[64:65]
  s_cbranch_scc0 L_rd_68
  s_mov_b64 exec, vcc
  buffer_load_dword v75, v51, s[40:43], 0 idxen
  s_mov_b64 exec, -1
L_rd_68:
  v_cmp_gt_u32 s[64:65], s62, v105
  v_cmp_eq_u32 vcc, 0, v81
  s_and_b64 vcc, vcc, s[64:65]
  s_cbranch_scc0 L_rd_69
  s_mov_b64 exec, vcc
  buffer_load_dword v81, v57, s[40:43], 0 idxen
  s_mov_b64 exec, -1
L_rd_69:
  v_cmp_gt_u32 s[64:65], s62, v111
  v_cmp_eq_u32 vcc, 0, v87
  s_and_b64 vcc, vcc, s[64:65]
  s_cbranch_scc0 L_rd_70
  s_mov_b64 exec, vcc
  buffer_load_dword v87, v63, s[40:43], 0 idxen
  s_mov_b64 exec, -1
L_rd_70:
  v_cmp_gt_u32 s[64:65], s62, v117
  v_cmp_eq_u32 vcc, 0, v93
  s_and_b64 vcc, vcc, s[64:65]
  s_cbranch_scc0 L_rd_71
  s_mov_b64 exec, vcc
  buffer_load_dword v93, v69, s[40:43], 0 idxen
  s_mov_b64 exec, -1
L_rd_71:
L_skipr_67:
  s_mov_b32 s79, 0
L_spinE7_72:
  ds_read_b32 v173, v42 offset:0
  s_waitcnt lgkmcnt(0)
  v_readfirstlane_b32 s60, v173
  s_add_u32 s79, s79, 1
  s_cmp_ge_u32 s60, 8
  s_cbranch_scc1 L_spinxE7_73
  s_cmp_gt_u32 s79, 0x100000
  s_cbranch_scc1 L_spinxE7_73
  s_sleep 1
  s_branch L_spinE7_72
L_spinxE7_73:
  s_setprio 3
  s_waitcnt vmcnt(0)
  s_movk_i32 s62, 448
  v_cmp_gt_u32 s[64:65], s62, v99
  v_cmp_eq_u32 vcc, 0, v75
  s_and_b64 vcc, vcc, s[64:65]
  s_cbranch_scc0 L_rd_75
  s_mov_b64 exec, vcc
  buffer_load_dword v75, v51, s[40:43], 0 idxen
  s_mov_b64 exec, -1
L_rd_75:
  v_cmp_gt_u32 s[64:65], s62, v105
  v_cmp_eq_u32 vcc, 0, v81
  s_and_b64 vcc, vcc, s[64:65]
  s_cbranch_scc0 L_rd_76
  s_mov_b64 exec, vcc
  buffer_load_dword v81, v57, s[40:43], 0 idxen
  s_mov_b64 exec, -1
L_rd_76:
  v_cmp_gt_u32 s[64:65], s62, v111
  v_cmp_eq_u32 vcc, 0, v87
  s_and_b64 vcc, vcc, s[64:65]
  s_cbranch_scc0 L_rd_77
  s_mov_b64 exec, vcc
  buffer_load_dword v87, v63, s[40:43], 0 idxen
  s_mov_b64 exec, -1
L_rd_77:
  v_cmp_gt_u32 s[64:65], s62, v117
  v_cmp_eq_u32 vcc, 0, v93
  s_and_b64 vcc, vcc, s[64:65]
  s_cbranch_scc0 L_rd_78
  s_mov_b64 exec, vcc
  buffer_load_dword v93, v69, s[40:43], 0 idxen
  s_mov_b64 exec, -1
L_rd_78:
  v_cmp_gt_u32 s[64:65], s62, v100
  v_cmp_eq_u32 vcc, 0, v76
  s_and_b64 vcc, vcc, s[64:65]
  s_cbranch_scc0 L_rd_79
  s_mov_b64 exec, vcc
  buffer_load_dword v76, v52, s[40:43], 0 idxen
  s_mov_b64 exec, -1
L_rd_79:
  v_cmp_gt_u32 s[64:65], s62, v106
  v_cmp_eq_u32 vcc, 0, v82
  s_and_b64 vcc, vcc, s[64:65]
  s_cbranch_scc0 L_rd_80
  s_mov_b64 exec, vcc
  buffer_load_dword v82, v58, s[40:43], 0 idxen
  s_mov_b64 exec, -1
L_rd_80:
  v_cmp_gt_u32 s[64:65], s62, v112
  v_cmp_eq_u32 vcc, 0, v88
  s_and_b64 vcc, vcc, s[64:65]
  s_cbranch_scc0 L_rd_81
  s_mov_b64 exec, vcc
  buffer_load_dword v88, v64, s[40:43], 0 idxen
  s_mov_b64 exec, -1
L_rd_81:
  v_cmp_gt_u32 s[64:65], s62, v118
  v_cmp_eq_u32 vcc, 0, v94
  s_and_b64 vcc, vcc, s[64:65]
  s_cbranch_scc0 L_rd_82
  s_mov_b64 exec, vcc
  buffer_load_dword v94, v70, s[40:43], 0 idxen
  s_mov_b64 exec, -1
L_rd_82:
L_skipr_74:
  s_branch L_tail
L_hspecial:
  s_waitcnt vmcnt(0)
  v_lshlrev_b32 v4, 2, v4
  v_lshlrev_b32 v10, 2, v10
  v_lshlrev_b32 v5, 2, v5
  v_lshlrev_b32 v11, 2, v11
  v_lshlrev_b32 v6, 2, v6
  v_lshlrev_b32 v12, 2, v12
  v_lshlrev_b32 v7, 2, v7
  v_lshlrev_b32 v13, 2, v13
  v_lshlrev_b32 v8, 2, v8
  v_lshlrev_b32 v14, 2, v14
  v_lshlrev_b32 v9, 2, v9
  v_lshlrev_b32 v15, 2, v15
  v_lshl_or_b32 v0, v1, 16, v0
  v_lshl_or_b32 v2, v3, 16, v2
  ds_bpermute_b32 v144, v4, v0
  ds_bpermute_b32 v145, v10, v0
  ds_bpermute_b32 v146, v5, v0
  ds_bpermute_b32 v147, v11, v0
  ds_bpermute_b32 v148, v6, v0
  ds_bpermute_b32 v149, v12, v0
  ds_bpermute_b32 v150, v7, v0
  ds_bpermute_b32 v151, v13, v0
  ds_bpermute_b32 v152, v8, v0
  ds_bpermute_b32 v153, v14, v0
  ds_bpermute_b32 v154, v9, v0
  ds_bpermute_b32 v155, v15, v0
  s_waitcnt lgkmcnt(10)
  ds_bpermute_b32 v156, v4, v2
  ds_bpermute_b32 v157, v10, v2
  v_pk_min_u16 v168, v144, v145
  v_pk_max_u16 v169, v144, v145
  v_pk_sub_u16 v170, v169, v168
  v_pk_sub_i16 v171, s70, v170
  v_pk_sub_u16 v144, s71, v170
  v_pk_ashrrev_i16 v171, s72, v171
  v_bfi_b32 v168, v171, v169, v168
  v_bfi_b32 v170, v171, v144, v170
  v_and_b32 v169, s73, v168
  v_pk_add_u16 v170, v170, v169
  v_lshlrev_b32_sdwa v48, 9, v168 dst_sel:DWORD dst_unused:UNUSED_PAD src0_sel:DWORD src1_sel:WORD_0
  v_lshlrev_b32_sdwa v54, 9, v168 dst_sel:DWORD dst_unused:UNUSED_PAD src0_sel:DWORD src1_sel:WORD_1
  v_add_u32_sdwa v48, v48, v170 dst_sel:DWORD dst_unused:UNUSED_PAD src0_sel:DWORD src1_sel:WORD_0
  v_add_u32_sdwa v54, v54, v170 dst_sel:DWORD dst_unused:UNUSED_PAD src0_sel:DWORD src1_sel:WORD_1
  v_lshrrev_b32 v96, 4, v170
  v_lshrrev_b32 v102, 20, v170
  v_and_or_b32 v96, v96, 28, v45
  v_and_or_b32 v102, v102, 28, v45
  s_waitcnt lgkmcnt(10)
  ds_bpermute_b32 v158, v5, v2
  ds_bpermute_b32 v159, v11, v2
  v_pk_min_u16 v168, v146, v147
  v_pk_max_u16 v169, v146, v147
  v_pk_sub_u16 v170, v169, v168
  v_pk_sub_i16 v171, s70, v170
  v_pk_sub_u16 v146, s71, v170
  v_pk_ashrrev_i16 v171, s72, v171
  v_bfi_b32 v168, v171, v169, v168
  v_bfi_b32 v170, v171, v146, v170
  v_and_b32 v169, s73, v168
  v_pk_add_u16 v170, v170, v169
  v_lshlrev_b32_sdwa v49, 9, v168 dst_sel:DWORD dst_unused:UNUSED_PAD src0_sel:DWORD src1_sel:WORD_0
  v_lshlrev_b32_sdwa v55, 9, v168 dst_sel:DWORD dst_unused:UNUSED_PAD src0_sel:DWORD src1_sel:WORD_1
  v_add_u32_sdwa v49, v49, v170 dst_sel:DWORD dst_unused:UNUSED_PAD src0_sel:DWORD src1_sel:WORD_0
  v_add_u32_sdwa v55, v55, v170 dst_sel:DWORD dst_unused:UNUSED_PAD src0_sel:DWORD src1_sel:WORD_1
  v_lshrrev_b32 v97, 4, v170
  v_lshrrev_b32 v103, 20, v170
  v_and_or_b32 v97, v97, 28, v45
  v_and_or_b32 v103, v103, 28, v45
  s_waitcnt lgkmcnt(10)
  ds_bpermute_b32 v160, v6, v2
  ds_bpermute_b32 v161, v12, v2
  v_pk_min_u16 v168, v148, v149
  v_pk_max_u16 v169, v148, v149
  v_pk_sub_u16 v170, v169, v168
  v_pk_sub_i16 v171, s70, v170
  v_pk_sub_u16 v148, s71, v170
  v_pk_ashrrev_i16 v171, s72, v171
  v_bfi_b32 v168, v171, v169, v168
  v_bfi_b32 v170, v171, v148, v170
  v_and_b32 v169, s73, v168
  v_pk_add_u16 v170, v170, v169
  v_lshlrev_b32_sdwa v50, 9, v168 dst_sel:DWORD dst_unused:UNUSED_PAD src0_sel:DWORD src1_sel:WORD_0
  v_lshlrev_b32_sdwa v56, 9, v168 dst_sel:DWORD dst_unused:UNUSED_PAD src0_sel:DWORD src1_sel:WORD_1
  v_add_u32_sdwa v50, v50, v170 dst_sel:DWORD dst_unused:UNUSED_PAD src0_sel:DWORD src1_sel:WORD_0
  v_add_u32_sdwa v56, v56, v170 dst_sel:DWORD dst_unused:UNUSED_PAD src0_sel:DWORD src1_sel:WORD_1
  v_lshrrev_b32 v98, 4, v170
  v_lshrrev_b32 v104, 20, v170
  v_and_or_b32 v98, v98, 28, v45
  v_and_or_b32 v104, v104, 28, v45
  s_waitcnt lgkmcnt(10)
  ds_bpermute_b32 v162, v7, v2
  ds_bpermute_b32 v163, v13, v2
  v_pk_min_u16 v168, v150, v151
  v_pk_max_u16 v169, v150, v151
  v_pk_sub_u16 v170, v169, v168
  v_pk_sub_i16 v171, s70, v170
  v_pk_sub_u16 v150, s71, v170
  v_pk_ashrrev_i16 v171, s72, v171
  v_bfi_b32 v168, v171, v169, v168
  v_bfi_b32 v170, v171, v150, v170
  v_and_b32 v169, s73, v168
  v_pk_add_u16 v170, v170, v169
  v_lshlrev_b32_sdwa v51, 9, v168 dst_sel:DWORD dst_unused:UNUSED_PAD src0_sel:DWORD src1_sel:WORD_0
  v_lshlrev_b32_sdwa v57, 9, v168 dst_sel:DWORD dst_unused:UNUSED_PAD src0_sel:DWORD src1_sel:WORD_1
  v_add_u32_sdwa v51, v51, v170 dst_sel:DWORD dst_unused:UNUSED_PAD src0_sel:DWORD src1_sel:WORD_0
  v_add_u32_sdwa v57, v57, v170 dst_sel:DWORD dst_unused:UNUSED_PAD src0_sel:DWORD src1_sel:WORD_1
  v_lshrrev_b32 v99, 4, v170
  v_lshrrev_b32 v105, 20, v170
  v_and_or_b32 v99, v99, 28, v45
  v_and_or_b32 v105, v105, 28, v45
  s_waitcnt lgkmcnt(10)
  ds_bpermute_b32 v164, v8, v2
  ds_bpermute_b32 v165, v14, v2
  v_pk_min_u16 v168, v152, v153
  v_pk_max_u16 v169, v152, v153
  v_pk_sub_u16 v170, v169, v168
  v_pk_sub_i16 v171, s70, v170
  v_pk_sub_u16 v152, s71, v170
  v_pk_ashrrev_i16 v171, s72, v171
  v_bfi_b32 v168, v171, v169, v168
  v_bfi_b32 v170, v171, v152, v170
  v_and_b32 v169, s73, v168
  v_pk_add_u16 v170, v170, v169
  v_lshlrev_b32_sdwa v52, 9, v168 dst_sel:DWORD dst_unused:UNUSED_PAD src0_sel:DWORD src1_sel:WORD_0
  v_lshlrev_b32_sdwa v58, 9, v168 dst_sel:DWORD dst_unused:UNUSED_PAD src0_sel:DWORD src1_sel:WORD_1
  v_add_u32_sdwa v52, v52, v170 dst_sel:DWORD dst_unused:UNUSED_PAD src0_sel:DWORD src1_sel:WORD_0
  v_add_u32_sdwa v58, v58, v170 dst_sel:DWORD dst_unused:UNUSED_PAD src0_sel:DWORD src1_sel:WORD_1
  v_lshrrev_b32 v100, 4, v170
  v_lshrrev_b32 v106, 20, v170
  v_and_or_b32 v100, v100, 28, v45
  v_and_or_b32 v106, v106, 28, v45
  s_waitcnt lgkmcnt(10)
  ds_bpermute_b32 v166, v9, v2
  ds_bpermute_b32 v167, v15, v2
  v_pk_min_u16 v168, v154, v155
  v_pk_max_u16 v169, v154, v155
  v_pk_sub_u16 v170, v169, v168
  v_pk_sub_i16 v171, s70, v170
  v_pk_sub_u16 v154, s71, v170
  v_pk_ashrrev_i16 v171, s72, v171
  v_bfi_b32 v168, v171, v169, v168
  v_bfi_b32 v170, v171, v154, v170
  v_and_b32 v169, s73, v168
  v_pk_add_u16 v170, v170, v169
  v_lshlrev_b32_sdwa v53, 9, v168 dst_sel:DWORD dst_unused:UNUSED_PAD src0_sel:DWORD src1_sel:WORD_0
  v_lshlrev_b32_sdwa v59, 9, v168 dst_sel:DWORD dst_unused:UNUSED_PAD src0_sel:DWORD src1_sel:WORD_1
  v_add_u32_sdwa v53, v53, v170 dst_sel:DWORD dst_unused:UNUSED_PAD src0_sel:DWORD src1_sel:WORD_0
  v_add_u32_sdwa v59, v59, v170 dst_sel:DWORD dst_unused:UNUSED_PAD src0_sel:DWORD src1_sel:WORD_1
  v_lshrrev_b32 v101, 4, v170
  v_lshrrev_b32 v107, 20, v170
  v_and_or_b32 v101, v101, 28, v45
  v_and_or_b32 v107, v107, 28, v45
  s_waitcnt lgkmcnt(10)
  v_pk_min_u16 v168, v156, v157
  v_pk_max_u16 v169, v156, v157
  v_pk_sub_u16 v170, v169, v168
  v_pk_sub_i16 v171, s70, v170
  v_pk_sub_u16 v156, s71, v170
  v_pk_ashrrev_i16 v171, s72, v171
  v_bfi_b32 v168, v171, v169, v168
  v_bfi_b32 v170, v171, v156, v170
  v_and_b32 v169, s73, v168
  v_pk_add_u16 v170, v170, v169
  v_lshlrev_b32_sdwa v60, 9, v168 dst_sel:DWORD dst_unused:UNUSED_PAD src0_sel:DWORD src1_sel:WORD_0
  v_lshlrev_b32_sdwa v66, 9, v168 dst_sel:DWORD dst_unused:UNUSED_PAD src0_sel:DWORD src1_sel:WORD_1
  v_add_u32_sdwa v60, v60, v170 dst_sel:DWORD dst_unused:UNUSED_PAD src0_sel:DWORD src1_sel:WORD_0
  v_add_u32_sdwa v66, v66, v170 dst_sel:DWORD dst_unused:UNUSED_PAD src0_sel:DWORD src1_sel:WORD_1
  v_lshrrev_b32 v108, 4, v170
  v_lshrrev_b32 v114, 20, v170
  v_and_or_b32 v108, v108, 28, v45
  v_and_or_b32 v114, v114, 28, v45
  s_waitcnt lgkmcnt(8)
  v_pk_min_u16 v168, v158, v159
  v_pk_max_u16 v169, v158, v159
  v_pk_sub_u16 v170, v169, v168
  v_pk_sub_i16 v171, s70, v170
  v_pk_sub_u16 v158, s71, v170
  v_pk_ashrrev_i16 v171, s72, v171
  v_bfi_b32 v168, v171, v169, v168
  v_bfi_b32 v170, v171, v158, v170
  v_and_b32 v169, s73, v168
  v_pk_add_u16 v170, v170, v169
  v_lshlrev_b32_sdwa v61, 9, v168 dst_sel:DWORD dst_unused:UNUSED_PAD src0_sel:DWORD src1_sel:WORD_0
  v_lshlrev_b32_sdwa v67, 9, v168 dst_sel:DWORD dst_unused:UNUSED_PAD src0_sel:DWORD src1_sel:WORD_1
  v_add_u32_sdwa v61, v61, v170 dst_sel:DWORD dst_unused:UNUSED_PAD src0_sel:DWORD src1_sel:WORD_0
  v_add_u32_sdwa v67, v67, v170 dst_sel:DWORD dst_unused:UNUSED_PAD src0_sel:DWORD src1_sel:WORD_1
  v_lshrrev_b32 v109, 4, v170
  v_lshrrev_b32 v115, 20, v170
  v_and_or_b32 v109, v109, 28, v45
  v_and_or_b32 v115, v115, 28, v45
  s_waitcnt lgkmcnt(6)
  v_pk_min_u16 v168, v160, v161
  v_pk_max_u16 v169, v160, v161
  v_pk_sub_u16 v170, v169, v168
  v_pk_sub_i16 v171, s70, v170
  v_pk_sub_u16 v160, s71, v170
  v_pk_ashrrev_i16 v171, s72, v171
  v_bfi_b32 v168, v171, v169, v168
  v_bfi_b32 v170, v171, v160, v170
  v_and_b32 v169, s73, v168
  v_pk_add_u16 v170, v170, v169
  v_lshlrev_b32_sdwa v62, 9, v168 dst_sel:DWORD dst_unused:UNUSED_PAD src0_sel:DWORD src1_sel:WORD_0
  v_lshlrev_b32_sdwa v68, 9, v168 dst_sel:DWORD dst_unused:UNUSED_PAD src0_sel:DWORD src1_sel:WORD_1
  v_add_u32_sdwa v62, v62, v170 dst_sel:DWORD dst_unused:UNUSED_PAD src0_sel:DWORD src1_sel:WORD_0
  v_add_u32_sdwa v68, v68, v170 dst_sel:DWORD dst_unused:UNUSED_PAD src0_sel:DWORD src1_sel:WORD_1
  v_lshrrev_b32 v110, 4, v170
  v_lshrrev_b32 v116, 20, v170
  v_and_or_b32 v110, v110, 28, v45
  v_and_or_b32 v116, v116, 28, v45
  s_waitcnt lgkmcnt(4)
  v_pk_min_u16 v168, v162, v163
  v_pk_max_u16 v169, v162, v163
  v_pk_sub_u16 v170, v169, v168
  v_pk_sub_i16 v171, s70, v170
  v_pk_sub_u16 v162, s71, v170
  v_pk_ashrrev_i16 v171, s72, v171
  v_bfi_b32 v168, v171, v169, v168
  v_bfi_b32 v170, v171, v162, v170
  v_and_b32 v169, s73, v168
  v_pk_add_u16 v170, v170, v169
  v_lshlrev_b32_sdwa v63, 9, v168 dst_sel:DWORD dst_unused:UNUSED_PAD src0_sel:DWORD src1_sel:WORD_0
  v_lshlrev_b32_sdwa v69, 9, v168 dst_sel:DWORD dst_unused:UNUSED_PAD src0_sel:DWORD src1_sel:WORD_1
  v_add_u32_sdwa v63, v63, v170 dst_sel:DWORD dst_unused:UNUSED_PAD src0_sel:DWORD src1_sel:WORD_0
  v_add_u32_sdwa v69, v69, v170 dst_sel:DWORD dst_unused:UNUSED_PAD src0_sel:DWORD src1_sel:WORD_1
  v_lshrrev_b32 v111, 4, v170
  v_lshrrev_b32 v117, 20, v170
  v_and_or_b32 v111, v111, 28, v45
  v_and_or_b32 v117, v117, 28, v45
  s_waitcnt lgkmcnt(2)
  v_pk_min_u16 v168, v164, v165
  v_pk_max_u16 v169, v164, v165
  v_pk_sub_u16 v170, v169, v168
  v_pk_sub_i16 v171, s70, v170
  v_pk_sub_u16 v164, s71, v170
  v_pk_ashrrev_i16 v171, s72, v171
  v_bfi_b32 v168, v171, v169, v168
  v_bfi_b32 v170, v171, v164, v170
  v_and_b32 v169, s73, v168
  v_pk_add_u16 v170, v170, v169
  v_lshlrev_b32_sdwa v64, 9, v168 dst_sel:DWORD dst_unused:UNUSED_PAD src0_sel:DWORD src1_sel:WORD_0
  v_lshlrev_b32_sdwa v70, 9, v168 dst_sel:DWORD dst_unused:UNUSED_PAD src0_sel:DWORD src1_sel:WORD_1
  v_add_u32_sdwa v64, v64, v170 dst_sel:DWORD dst_unused:UNUSED_PAD src0_sel:DWORD src1_sel:WORD_0
  v_add_u32_sdwa v70, v70, v170 dst_sel:DWORD dst_unused:UNUSED_PAD src0_sel:DWORD src1_sel:WORD_1
  v_lshrrev_b32 v112, 4, v170
  v_lshrrev_b32 v118, 20, v170
  v_and_or_b32 v112, v112, 28, v45
  v_and_or_b32 v118, v118, 28, v45
  s_waitcnt lgkmcnt(0)
  v_pk_min_u16 v168, v166, v167
  v_pk_max_u16 v169, v166, v167
  v_pk_sub_u16 v170, v169, v168
  v_pk_sub_i16 v171, s70, v170
  v_pk_sub_u16 v166, s71, v170
  v_pk_ashrrev_i16 v171, s72, v171
  v_bfi_b32 v168, v171, v169, v168
  v_bfi_b32 v170, v171, v166, v170
  v_and_b32 v169, s73, v168
  v_pk_add_u16 v170, v170, v169
  v_lshlrev_b32_sdwa v65, 9, v168 dst_sel:DWORD dst_unused:UNUSED_PAD src0_sel:DWORD src1_sel:WORD_0
  v_lshlrev_b32_sdwa v71, 9, v168 dst_sel:DWORD dst_unused:UNUSED_PAD src0_sel:DWORD src1_sel:WORD_1
  v_add_u32_sdwa v65, v65, v170 dst_sel:DWORD dst_unused:UNUSED_PAD src0_sel:DWORD src1_sel:WORD_0
  v_add_u32_sdwa v71, v71, v170 dst_sel:DWORD dst_unused:UNUSED_PAD src0_sel:DWORD src1_sel:WORD_1
  v_lshrrev_b32 v113, 4, v170
  v_lshrrev_b32 v119, 20, v170
  v_and_or_b32 v113, v113, 28, v45
  v_and_or_b32 v119, v119, 28, v45
  v_lshlrev_b32 v144, 3, v223
  v_add_u32 v144, s74, v144
  v_mov_b32 v146, 0
  v_mov_b32 v147, 0
  ds_write_b64 v144, v[146:147]
  ds_add_rtn_u32 v120, v96, v44 offset:0
  ds_add_rtn_u32 v121, v97, v44 offset:0
  ds_add_rtn_u32 v122, v98, v44 offset:0
  ds_add_rtn_u32 v123, v99, v44 offset:0
  s_mov_b32 exec_hi, 7
  ds_add_rtn_u32 v124, v100, v44 offset:0
  s_mov_b32 exec_hi, -1
  s_mov_b32 exec_hi, 3
  ds_add_rtn_u32 v125, v101, v44 offset:0
  s_mov_b32 exec_hi, -1
  s_waitcnt lgkmcnt(8)
  ds_add_rtn_u32 v126, v102, v44 offset:128
  ds_add_rtn_u32 v127, v103, v44 offset:128
  ds_add_rtn_u32 v128, v104, v44 offset:128
  ds_add_rtn_u32 v129, v105, v44 offset:128
  s_mov_b32 exec_hi, 7
  ds_add_rtn_u32 v130, v106, v44 offset:128
  s_mov_b32 exec_hi, -1
  s_mov_b32 exec_hi, 3
  ds_add_rtn_u32 v131, v107, v44 offset:128
  s_mov_b32 exec_hi, -1
  s_waitcnt lgkmcnt(8)
  ds_add_rtn_u32 v132, v108, v44 offset:256
  ds_add_rtn_u32 v133, v109, v44 offset:256
  ds_add_rtn_u32 v134, v110, v44 offset:256
  ds_add_rtn_u32 v135, v111, v44 offset:256
  s_mov_b32 exec_hi, 7
  ds_add_rtn_u32 v136, v112, v44 offset:256
  s_mov_b32 exec_hi, -1
  s_mov_b32 exec_hi, 3
  ds_add_rtn_u32 v137, v113, v44 offset:256
  s_mov_b32 exec_hi, -1
  s_waitcnt lgkmcnt(8)
  ds_add_rtn_u32 v138, v114, v44 offset:384
  ds_add_rtn_u32 v139, v115, v44 offset:384
  ds_add_rtn_u32 v140, v116, v44 offset:384
  ds_add_rtn_u32 v141, v117, v44 offset:384
  s_mov_b32 exec_hi, 7
  ds_add_rtn_u32 v142, v118, v44 offset:384
  s_mov_b32 exec_hi, -1
  s_mov_b32 exec_hi, 3
  ds_add_rtn_u32 v143, v119, v44 offset:384
  s_mov_b32 exec_hi, -1
  s_waitcnt lgkmcnt(8)
  v_and_b32 v145, 3, v223
  v_lshlrev_b32 v145, 5, v145
  v_bfe_u32 v146, v223, 2, 3
  v_lshl_add_u32 v145, v146, 2, v145
  v_lshrrev_b32 v146, 5, v223
  v_lshl_add_u32 v145, v146, 7, v145
  v_add_u32 v145, s74, v145
  ds_read_b32 v148, v145
  ds_read_b32 v149, v145 offset:256
  v_and_b32 v146, 7, v223
  v_bfe_u32 v147, v223, 3, 2
  v_lshl_add_u32 v146, v146, 2, v147
  v_and_b32 v147, 32, v223
  v_add_lshl_u32 v146, v146, v147, 2
  s_waitcnt lgkmcnt(0)
  v_mov_b32 v150, v148
  v_mov_b32 v151, v149
  s_nop 0
  v_add_u32_dpp v148, v148, v148 row_shr:1 row_mask:0xf bank_mask:0xf
  v_add_u32_dpp v149, v149, v149 row_shr:1 row_mask:0xf bank_mask:0xf
  s_nop 0
  v_add_u32_dpp v148, v148, v148 row_shr:2 row_mask:0xf bank_mask:0xf
  v_add_u32_dpp v149, v149, v149 row_shr:2 row_mask:0xf bank_mask:0xf
  s_nop 0
  v_add_u32_dpp v148, v148, v148 row_shr:4 row_mask:0xf bank_mask:0xf
  v_add_u32_dpp v149, v149, v149 row_shr:4 row_mask:0xf bank_mask:0xf
  s_nop 0
  v_add_u32_dpp v148, v148, v148 row_shr:8 row_mask:0xf bank_mask:0xf
  v_add_u32_dpp v149, v149, v149 row_shr:8 row_mask:0xf bank_mask:0xf
  s_nop 0
  v_add_u32_dpp v148, v148, v148 row_bcast:15 row_mask:0xa bank_mask:0xf
  v_add_u32_dpp v149, v149, v149 row_bcast:15 row_mask:0xa bank_mask:0xf
  v_sub_u32 v148, v148, v150
  v_sub_u32 v149, v149, v151
  v_add_u32 v148, s75, v148
  v_add_u32 v149, s75, v149
  ds_bpermute_b32 v40, v146, v148
  ds_bpermute_b32 v39, v146, v149
  s_waitcnt lgkmcnt(0)
  ds_bpermute_b32 v144, v96, v40 offset:0
  ds_bpermute_b32 v145, v97, v40 offset:0
  ds_bpermute_b32 v146, v98, v40 offset:0
  ds_bpermute_b32 v147, v99, v40 offset:0
  ds_bpermute_b32 v148, v100, v40 offset:0
  ds_bpermute_b32 v149, v101, v40 offset:0
  ds_bpermute_b32 v150, v102, v40 offset:128
  ds_bpermute_b32 v151, v103, v40 offset:128
  ds_bpermute_b32 v152, v104, v40 offset:128
  ds_bpermute_b32 v153, v105, v40 offset:128
  ds_bpermute_b32 v154, v106, v40 offset:128
  ds_bpermute_b32 v155, v107, v40 offset:128
  s_waitcnt lgkmcnt(11)
  v_add_lshl_u32 v96, v144, v120, 2
  s_waitcnt lgkmcnt(10)
  v_add_lshl_u32 v97, v145, v121, 2
  s_waitcnt lgkmcnt(9)
  v_add_lshl_u32 v98, v146, v122, 2
  s_waitcnt lgkmcnt(8)
  v_add_lshl_u32 v99, v147, v123, 2
  s_waitcnt lgkmcnt(7)
  v_add_lshl_u32 v100, v148, v124, 2
  s_waitcnt lgkmcnt(6)
  v_add_lshl_u32 v101, v149, v125, 2
  s_waitcnt lgkmcnt(5)
  v_add_lshl_u32 v102, v150, v126, 2
  s_waitcnt lgkmcnt(4)
  v_add_lshl_u32 v103, v151, v127, 2
  s_waitcnt lgkmcnt(3)
  v_add_lshl_u32 v104, v152, v128, 2
  s_waitcnt lgkmcnt(2)
  v_add_lshl_u32 v105, v153, v129, 2
  s_waitcnt lgkmcnt(1)
  v_add_lshl_u32 v106, v154, v130, 2
  s_waitcnt lgkmcnt(0)
  v_add_lshl_u32 v107, v155, v131, 2
  ds_bpermute_b32 v144, v108, v39 offset:0
  ds_bpermute_b32 v145, v109, v39 offset:0
  ds_bpermute_b32 v146, v110, v39 offset:0
  ds_bpermute_b32 v147, v111, v39 offset:0
  ds_bpermute_b32 v148, v112, v39 offset:0
  ds_bpermute_b32 v149, v113, v39 offset:0
  ds_bpermute_b32 v150, v114, v39 offset:128
  ds_bpermute_b32 v151, v115, v39 offset:128
  ds_bpermute_b32 v152, v116, v39 offset:128
  ds_bpermute_b32 v153, v117, v39 offset:128
  ds_bpermute_b32 v154, v118, v39 offset:128
  ds_bpermute_b32 v155, v119, v39 offset:128
  s_waitcnt lgkmcnt(11)
  v_add_lshl_u32 v108, v144, v132, 2
  s_waitcnt lgkmcnt(10)
  v_add_lshl_u32 v109, v145, v133, 2
  s_waitcnt lgkmcnt(9)
  v_add_lshl_u32 v110, v146, v134, 2
  s_waitcnt lgkmcnt(8)
  v_add_lshl_u32 v111, v147, v135, 2
  s_waitcnt lgkmcnt(7)
  v_add_lshl_u32 v112, v148, v136, 2
  s_waitcnt lgkmcnt(6)
  v_add_lshl_u32 v113, v149, v137, 2
  s_waitcnt lgkmcnt(5)
  v_add_lshl_u32 v114, v150, v138, 2
  s_waitcnt lgkmcnt(4)
  v_add_lshl_u32 v115, v151, v139, 2
  s_waitcnt lgkmcnt(3)
  v_add_lshl_u32 v116, v152, v140, 2
  s_waitcnt lgkmcnt(2)
  v_add_lshl_u32 v117, v153, v141, 2
  s_waitcnt lgkmcnt(1)
  v_add_lshl_u32 v118, v154, v142, 2
  s_waitcnt lgkmcnt(0)
  v_add_lshl_u32 v119, v155, v143, 2
  ds_write_b32 v96, v48
  ds_write_b32 v97, v49
  ds_write_b32 v98, v50
  ds_write_b32 v99, v51
  s_mov_b32 exec_hi, 7
  ds_write_b32 v100, v52
  s_mov_b32 exec_hi, -1
  s_mov_b32 exec_hi, 3
  ds_write_b32 v101, v53
  s_mov_b32 exec_hi, -1
  s_waitcnt lgkmcnt(8)
  ds_read_b32 v48, v46 offset:0
  ds_read_b32 v49, v46 offset:256
  ds_read_b32 v50, v46 offset:512
  ds_read_b32 v51, v46 offset:768
  ds_read_b32 v52, v46 offset:1024
  ds_read_b32 v53, v46 offset:1280
  ds_write_b32 v102, v54
  ds_write_b32 v103, v55
  ds_write_b32 v104, v56
  ds_write_b32 v105, v57
  s_mov_b32 exec_hi, 7
  ds_write_b32 v106, v58
  s_mov_b32 exec_hi, -1
  s_mov_b32 exec_hi, 3
  ds_write_b32 v107, v59
  s_mov_b32 exec_hi, -1
  s_waitcnt lgkmcnt(8)
  ds_read_b32 v54, v46 offset:0
  ds_read_b32 v55, v46 offset:256
  ds_read_b32 v56, v46 offset:512
  ds_read_b32 v57, v46 offset:768
  ds_read_b32 v58, v46 offset:1024
  ds_read_b32 v59, v46 offset:1280
  ds_write_b32 v108, v60
  ds_write_b32 v109, v61
  ds_write_b32 v110, v62
  ds_write_b32 v111, v63
  s_mov_b32 exec_hi, 7
  ds_write_b32 v112, v64
  s_mov_b32 exec_hi, -1
  s_mov_b32 exec_hi, 3
  ds_write_b32 v113, v65
  s_mov_b32 exec_hi, -1
  s_waitcnt lgkmcnt(8)
  ds_read_b32 v60, v46 offset:0
  ds_read_b32 v61, v46 offset:256
  ds_read_b32 v62, v46 offset:512
  ds_read_b32 v63, v46 offset:768
  ds_read_b32 v64, v46 offset:1024
  ds_read_b32 v65, v46 offset:1280
  ds_write_b32 v114, v66
  ds_write_b32 v115, v67
  ds_write_b32 v116, v68
  ds_write_b32 v117, v69
  s_mov_b32 exec_hi, 7
  ds_write_b32 v118, v70
  s_mov_b32 exec_hi, -1
  s_mov_b32 exec_hi, 3
  ds_write_b32 v119, v71
  s_mov_b32 exec_hi, -1
  s_waitcnt lgkmcnt(8)
  ds_read_b32 v66, v46 offset:0
  ds_read_b32 v67, v46 offset:256
  ds_read_b32 v68, v46 offset:512
  ds_read_b32 v69, v46 offset:768
  ds_read_b32 v70, v46 offset:1024
  ds_read_b32 v71, v46 offset:1280
  s_waitcnt lgkmcnt(0)
  v_and_b32 v96, 511, v48
  v_and_b32 v97, 511, v49
  v_and_b32 v98, 511, v50
  v_and_b32 v99, 511, v51
  v_and_b32 v100, 511, v52
  v_and_b32 v101, 511, v53
  v_and_b32 v102, 511, v54
  v_and_b32 v103, 511, v55
  v_and_b32 v104, 511, v56
  v_and_b32 v105, 511, v57
  v_and_b32 v106, 511, v58
  v_and_b32 v107, 511, v59
  v_and_b32 v108, 511, v60
  v_and_b32 v109, 511, v61
  v_and_b32 v110, 511, v62
  v_and_b32 v111, 511, v63
  v_and_b32 v112, 511, v64
  v_and_b32 v113, 511, v65
  v_and_b32 v114, 511, v66
  v_and_b32 v115, 511, v67
  v_and_b32 v116, 511, v68
  v_and_b32 v117, 511, v69
  v_and_b32 v118, 511, v70
  v_and_b32 v119, 511, v71
  v_mov_b32 v145, 4
  v_cmp_le_u32 vcc, 58, v223
  s_mov_b32 s79, 0
  s_nop 0
  v_cndmask_b32 v145, v145, 3, vcc
L_zc_83:
  global_load_dword v144, v220, s[22:23] sc1
  s_waitcnt vmcnt(0)
  v_cmp_lt_u32 vcc, v144, v145
  s_add_u32 s79, s79, 1
  s_cbranch_vccz L_zcx_84
  s_cmp_gt_u32 s79, 0x40000
  s_cbranch_scc1 L_zcx_84
  s_sleep 8
  s_branch L_zc_83
L_zcx_84:
  s_mov_b32 s79, 0
L_px_85:
  s_mov_b64 exec, 0xffff
  buffer_load_dword v219, v218, s[40:43], 0 idxen offset:256 sc1
  s_mov_b64 exec, -1
  s_waitcnt vmcnt(0)
  v_cmp_eq_u32 vcc, 0, v219
  s_add_u32 s79, s79, 1
  s_cbranch_vccz L_pxx_86
  s_cmp_gt_u32 s79, 0x40000
  s_cbranch_scc1 L_pxx_86
  s_sleep 16
  s_branch L_px_85
L_pxx_86:
  s_movk_i32 s62, 128
  v_cmp_gt_u32 s[64:65], s62, v96
  v_cmp_eq_u32 vcc, 0, v72
  s_and_b64 vcc, vcc, s[64:65]
  s_cbranch_scc0 L_rd_87
  s_mov_b64 exec, vcc
  buffer_load_dword v72, v48, s[40:43], 0 idxen
  s_mov_b64 exec, -1
L_rd_87:
  v_cmp_gt_u32 s[64:65], s62, v102
  v_cmp_eq_u32 vcc, 0, v78
  s_and_b64 vcc, vcc, s[64:65]
  s_cbranch_scc0 L_rd_88
  s_mov_b64 exec, vcc
  buffer_load_dword v78, v54, s[40:43], 0 idxen
  s_mov_b64 exec, -1
L_rd_88:
  v_cmp_gt_u32 s[64:65], s62, v108
  v_cmp_eq_u32 vcc, 0, v84
  s_and_b64 vcc, vcc, s[64:65]
  s_cbranch_scc0 L_rd_89
  s_mov_b64 exec, vcc
  buffer_load_dword v84, v60, s[40:43], 0 idxen
  s_mov_b64 exec, -1
L_rd_89:
  v_cmp_gt_u32 s[64:65], s62, v114
  v_cmp_eq_u32 vcc, 0, v90
  s_and_b64 vcc, vcc, s[64:65]
  s_cbranch_scc0 L_rd_90
  s_mov_b64 exec, vcc
  buffer_load_dword v90, v66, s[40:43], 0 idxen
  s_mov_b64 exec, -1
L_rd_90:
  v_cmp_gt_u32 s[64:65], s62, v97
  v_cmp_eq_u32 vcc, 0, v73
  s_and_b64 vcc, vcc, s[64:65]
  s_cbranch_scc0 L_rd_91
  s_mov_b64 exec, vcc
  buffer_load_dword v73, v49, s[40:43], 0 idxen
  s_mov_b64 exec, -1
L_rd_91:
  v_cmp_gt_u32 s[64:65], s62, v103
  v_cmp_eq_u32 vcc, 0, v79
  s_and_b64 vcc, vcc, s[64:65]
  s_cbranch_scc0 L_rd_92
  s_mov_b64 exec, vcc
  buffer_load_dword v79, v55, s[40:43], 0 idxen
  s_mov_b64 exec, -1
L_rd_92:
  v_cmp_gt_u32 s[64:65], s62, v109
  v_cmp_eq_u32 vcc, 0, v85
  s_and_b64 vcc, vcc, s[64:65]
  s_cbranch_scc0 L_rd_93
  s_mov_b64 exec, vcc
  buffer_load_dword v85, v61, s[40:43], 0 idxen
  s_mov_b64 exec, -1
L_rd_93:
  v_cmp_gt_u32 s[64:65], s62, v115
  v_cmp_eq_u32 vcc, 0, v91
  s_and_b64 vcc, vcc, s[64:65]
  s_cbranch_scc0 L_rd_94
  s_mov_b64 exec, vcc
  buffer_load_dword v91, v67, s[40:43], 0 idxen
  s_mov_b64 exec, -1
L_rd_94:
  s_mov_b32 s79, 0
L_px_95:
  s_mov_b64 exec, 0xffff
  buffer_load_dword v219, v218, s[40:43], 0 idxen offset:512 sc1
  s_mov_b64 exec, -1
  s_waitcnt vmcnt(0)
  v_cmp_eq_u32 vcc, 0, v219
  s_add_u32 s79, s79, 1
  s_cbranch_vccz L_pxx_96
  s_cmp_gt_u32 s79, 0x40000
  s_cbranch_scc1 L_pxx_96
  s_sleep 16
  s_branch L_px_95
L_pxx_96:
  s_movk_i32 s62, 192
  v_cmp_gt_u32 s[64:65], s62, v96
  v_cmp_eq_u32 vcc, 0, v72
  s_and_b64 vcc, vcc, s[64:65]
  s_cbranch_scc0 L_rd_97
  s_mov_b64 exec, vcc
  buffer_load_dword v72, v48, s[40:43], 0 idxen
  s_mov_b64 exec, -1
L_rd_97:
  v_cmp_gt_u32 s[64:65], s62, v102
  v_cmp_eq_u32 vcc, 0, v78
  s_and_b64 vcc, vcc, s[64:65]
  s_cbranch_scc0 L_rd_98
  s_mov_b64 exec, vcc
  buffer_load_dword v78, v54, s[40:43], 0 idxen
  s_mov_b64 exec, -1
L_rd_98:
  v_cmp_gt_u32 s[64:65], s62, v108
  v_cmp_eq_u32 vcc, 0, v84
  s_and_b64 vcc, vcc, s[64:65]
  s_cbranch_scc0 L_rd_99
  s_mov_b64 exec, vcc
  buffer_load_dword v84, v60, s[40:43], 0 idxen
  s_mov_b64 exec, -1
L_rd_99:
  v_cmp_gt_u32 s[64:65], s62, v114
  v_cmp_eq_u32 vcc, 0, v90
  s_and_b64 vcc, vcc, s[64:65]
  s_cbranch_scc0 L_rd_100
  s_mov_b64 exec, vcc
  buffer_load_dword v90, v66, s[40:43], 0 idxen
  s_mov_b64 exec, -1
L_rd_100:
  v_cmp_gt_u32 s[64:65], s62, v97
  v_cmp_eq_u32 vcc, 0, v73
  s_and_b64 vcc, vcc, s[64:65]
  s_cbranch_scc0 L_rd_101
  s_mov_b64 exec, vcc
  buffer_load_dword v73, v49, s[40:43], 0 idxen
  s_mov_b64 exec, -1
L_rd_101:
  v_cmp_gt_u32 s[64:65], s62, v103
  v_cmp_eq_u32 vcc, 0, v79
  s_and_b64 vcc, vcc, s[64:65]
  s_cbranch_scc0 L_rd_102
  s_mov_b64 exec, vcc
  buffer_load_dword v79, v55, s[40:43], 0 idxen
  s_mov_b64 exec, -1
L_rd_102:
  v_cmp_gt_u32 s[64:65], s62, v109
  v_cmp_eq_u32 vcc, 0, v85
  s_and_b64 vcc, vcc, s[64:65]
  s_cbranch_scc0 L_rd_103
  s_mov_b64 exec, vcc
  buffer_load_dword v85, v61, s[40:43], 0 idxen
  s_mov_b64 exec, -1
L_rd_103:
  v_cmp_gt_u32 s[64:65], s62, v115
  v_cmp_eq_u32 vcc, 0, v91
  s_and_b64 vcc, vcc, s[64:65]
  s_cbranch_scc0 L_rd_104
  s_mov_b64 exec, vcc
  buffer_load_dword v91, v67, s[40:43], 0 idxen
  s_mov_b64 exec, -1
L_rd_104:
  v_cmp_gt_u32 s[64:65], s62, v98
  v_cmp_eq_u32 vcc, 0, v74
  s_and_b64 vcc, vcc, s[64:65]
  s_cbranch_scc0 L_rd_105
  s_mov_b64 exec, vcc
  buffer_load_dword v74, v50, s[40:43], 0 idxen
  s_mov_b64 exec, -1
L_rd_105:
  v_cmp_gt_u32 s[64:65], s62, v104
  v_cmp_eq_u32 vcc, 0, v80
  s_and_b64 vcc, vcc, s[64:65]
  s_cbranch_scc0 L_rd_106
  s_mov_b64 exec, vcc
  buffer_load_dword v80, v56, s[40:43], 0 idxen
  s_mov_b64 exec, -1
L_rd_106:
  v_cmp_gt_u32 s[64:65], s62, v110
  v_cmp_eq_u32 vcc, 0, v86
  s_and_b64 vcc, vcc, s[64:65]
  s_cbranch_scc0 L_rd_107
  s_mov_b64 exec, vcc
  buffer_load_dword v86, v62, s[40:43], 0 idxen
  s_mov_b64 exec, -1
L_rd_107:
  v_cmp_gt_u32 s[64:65], s62, v116
  v_cmp_eq_u32 vcc, 0, v92
  s_and_b64 vcc, vcc, s[64:65]
  s_cbranch_scc0 L_rd_108
  s_mov_b64 exec, vcc
  buffer_load_dword v92, v68, s[40:43], 0 idxen
  s_mov_b64 exec, -1
L_rd_108:
  s_mov_b32 s79, 0
L_px_109:
  s_mov_b64 exec, 0xffff
  buffer_load_dword v219, v218, s[40:43], 0 idxen offset:768 sc1
  s_mov_b64 exec, -1
  s_waitcnt vmcnt(0)
  v_cmp_eq_u32 vcc, 0, v219
  s_add_u32 s79, s79, 1
  s_cbranch_vccz L_pxx_110
  s_cmp_gt_u32 s79, 0x40000
  s_cbranch_scc1 L_pxx_110
  s_sleep 16
  s_branch L_px_109
L_pxx_110:
  s_movk_i32 s62, 256
  v_cmp_gt_u32 s[64:65], s62, v96
  v_cmp_eq_u32 vcc, 0, v72
  s_and_b64 vcc, vcc, s[64:65]
  s_cbranch_scc0 L_rd_111
  s_mov_b64 exec, vcc
  buffer_load_dword v72, v48, s[40:43], 0 idxen
  s_mov_b64 exec, -1
L_rd_111:
  v_cmp_gt_u32 s[64:65], s62, v102
  v_cmp_eq_u32 vcc, 0, v78
  s_and_b64 vcc, vcc, s[64:65]
  s_cbranch_scc0 L_rd_112
  s_mov_b64 exec, vcc
  buffer_load_dword v78, v54, s[40:43], 0 idxen
  s_mov_b64 exec, -1
L_rd_112:
  v_cmp_gt_u32 s[64:65], s62, v108
  v_cmp_eq_u32 vcc, 0, v84
  s_and_b64 vcc, vcc, s[64:65]
  s_cbranch_scc0 L_rd_113
  s_mov_b64 exec, vcc
  buffer_load_dword v84, v60, s[40:43], 0 idxen
  s_mov_b64 exec, -1
L_rd_113:
  v_cmp_gt_u32 s[64:65], s62, v114
  v_cmp_eq_u32 vcc, 0, v90
  s_and_b64 vcc, vcc, s[64:65]
  s_cbranch_scc0 L_rd_114
  s_mov_b64 exec, vcc
  buffer_load_dword v90, v66, s[40:43], 0 idxen
  s_mov_b64 exec, -1
L_rd_114:
  v_cmp_gt_u32 s[64:65], s62, v97
  v_cmp_eq_u32 vcc, 0, v73
  s_and_b64 vcc, vcc, s[64:65]
  s_cbranch_scc0 L_rd_115
  s_mov_b64 exec, vcc
  buffer_load_dword v73, v49, s[40:43], 0 idxen
  s_mov_b64 exec, -1
L_rd_115:
  v_cmp_gt_u32 s[64:65], s62, v103
  v_cmp_eq_u32 vcc, 0, v79
  s_and_b64 vcc, vcc, s[64:65]
  s_cbranch_scc0 L_rd_116
  s_mov_b64 exec, vcc
  buffer_load_dword v79, v55, s[40:43], 0 idxen
  s_mov_b64 exec, -1
L_rd_116:
  v_cmp_gt_u32 s[64:65], s62, v109
  v_cmp_eq_u32 vcc, 0, v85
  s_and_b64 vcc, vcc, s[64:65]
  s_cbranch_scc0 L_rd_117
  s_mov_b64 exec, vcc
  buffer_load_dword v85, v61, s[40:43], 0 idxen
  s_mov_b64 exec, -1
L_rd_117:
  v_cmp_gt_u32 s[64:65], s62, v115
  v_cmp_eq_u32 vcc, 0, v91
  s_and_b64 vcc, vcc, s[64:65]
  s_cbranch_scc0 L_rd_118
  s_mov_b64 exec, vcc
  buffer_load_dword v91, v67, s[40:43], 0 idxen
  s_mov_b64 exec, -1
L_rd_118:
  v_cmp_gt_u32 s[64:65], s62, v98
  v_cmp_eq_u32 vcc, 0, v74
  s_and_b64 vcc, vcc, s[64:65]
  s_cbranch_scc0 L_rd_119
  s_mov_b64 exec, vcc
  buffer_load_dword v74, v50, s[40:43], 0 idxen
  s_mov_b64 exec, -1
L_rd_119:
  v_cmp_gt_u32 s[64:65], s62, v104
  v_cmp_eq_u32 vcc, 0, v80
  s_and_b64 vcc, vcc, s[64:65]
  s_cbranch_scc0 L_rd_120
  s_mov_b64 exec, vcc
  buffer_load_dword v80, v56, s[40:43], 0 idxen
  s_mov_b64 exec, -1
L_rd_120:
  v_cmp_gt_u32 s[64:65], s62, v110
  v_cmp_eq_u32 vcc, 0, v86
  s_and_b64 vcc, vcc, s[64:65]
  s_cbranch_scc0 L_rd_121
  s_mov_b64 exec, vcc
  buffer_load_dword v86, v62, s[40:43], 0 idxen
  s_mov_b64 exec, -1
L_rd_121:
  v_cmp_gt_u32 s[64:65], s62, v116
  v_cmp_eq_u32 vcc, 0, v92
  s_and_b64 vcc, vcc, s[64:65]
  s_cbranch_scc0 L_rd_122
  s_mov_b64 exec, vcc
  buffer_load_dword v92, v68, s[40:43], 0 idxen
  s_mov_b64 exec, -1
L_rd_122:
  s_mov_b32 s79, 0
L_px_123:
  s_mov_b64 exec, 0xffff
  buffer_load_dword v219, v218, s[40:43], 0 idxen offset:1024 sc1
  s_mov_b64 exec, -1
  s_waitcnt vmcnt(0)
  v_cmp_eq_u32 vcc, 0, v219
  s_add_u32 s79, s79, 1
  s_cbranch_vccz L_pxx_124
  s_cmp_gt_u32 s79, 0x40000
  s_cbranch_scc1 L_pxx_124
  s_sleep 16
  s_branch L_px_123
L_pxx_124:
  s_movk_i32 s62, 320
  v_cmp_gt_u32 s[64:65], s62, v97
  v_cmp_eq_u32 vcc, 0, v73
  s_and_b64 vcc, vcc, s[64:65]
  s_cbranch_scc0 L_rd_125
  s_mov_b64 exec, vcc
  buffer_load_dword v73, v49, s[40:43], 0 idxen
  s_mov_b64 exec, -1
L_rd_125:
  v_cmp_gt_u32 s[64:65], s62, v103
  v_cmp_eq_u32 vcc, 0, v79
  s_and_b64 vcc, vcc, s[64:65]
  s_cbranch_scc0 L_rd_126
  s_mov_b64 exec, vcc
  buffer_load_dword v79, v55, s[40:43], 0 idxen
  s_mov_b64 exec, -1
L_rd_126:
  v_cmp_gt_u32 s[64:65], s62, v109
  v_cmp_eq_u32 vcc, 0, v85
  s_and_b64 vcc, vcc, s[64:65]
  s_cbranch_scc0 L_rd_127
  s_mov_b64 exec, vcc
  buffer_load_dword v85, v61, s[40:43], 0 idxen
  s_mov_b64 exec, -1
L_rd_127:
  v_cmp_gt_u32 s[64:65], s62, v115
  v_cmp_eq_u32 vcc, 0, v91
  s_and_b64 vcc, vcc, s[64:65]
  s_cbranch_scc0 L_rd_128
  s_mov_b64 exec, vcc
  buffer_load_dword v91, v67, s[40:43], 0 idxen
  s_mov_b64 exec, -1
L_rd_128:
  v_cmp_gt_u32 s[64:65], s62, v98
  v_cmp_eq_u32 vcc, 0, v74
  s_and_b64 vcc, vcc, s[64:65]
  s_cbranch_scc0 L_rd_129
  s_mov_b64 exec, vcc
  buffer_load_dword v74, v50, s[40:43], 0 idxen
  s_mov_b64 exec, -1
L_rd_129:
  v_cmp_gt_u32 s[64:65], s62, v104
  v_cmp_eq_u32 vcc, 0, v80
  s_and_b64 vcc, vcc, s[64:65]
  s_cbranch_scc0 L_rd_130
  s_mov_b64 exec, vcc
  buffer_load_dword v80, v56, s[40:43], 0 idxen
  s_mov_b64 exec, -1
L_rd_130:
  v_cmp_gt_u32 s[64:65], s62, v110
  v_cmp_eq_u32 vcc, 0, v86
  s_and_b64 vcc, vcc, s[64:65]
  s_cbranch_scc0 L_rd_131
  s_mov_b64 exec, vcc
  buffer_load_dword v86, v62, s[40:43], 0 idxen
  s_mov_b64 exec, -1
L_rd_131:
  v_cmp_gt_u32 s[64:65], s62, v116
  v_cmp_eq_u32 vcc, 0, v92
  s_and_b64 vcc, vcc, s[64:65]
  s_cbranch_scc0 L_rd_132
  s_mov_b64 exec, vcc
  buffer_load_dword v92, v68, s[40:43], 0 idxen
  s_mov_b64 exec, -1
L_rd_132:
  v_cmp_gt_u32 s[64:65], s62, v99
  v_cmp_eq_u32 vcc, 0, v75
  s_and_b64 vcc, vcc, s[64:65]
  s_cbranch_scc0 L_rd_133
  s_mov_b64 exec, vcc
  buffer_load_dword v75, v51, s[40:43], 0 idxen
  s_mov_b64 exec, -1
L_rd_133:
  v_cmp_gt_u32 s[64:65], s62, v105
  v_cmp_eq_u32 vcc, 0, v81
  s_and_b64 vcc, vcc, s[64:65]
  s_cbranch_scc0 L_rd_134
  s_mov_b64 exec, vcc
  buffer_load_dword v81, v57, s[40:43], 0 idxen
  s_mov_b64 exec, -1
L_rd_134:
  v_cmp_gt_u32 s[64:65], s62, v111
  v_cmp_eq_u32 vcc, 0, v87
  s_and_b64 vcc, vcc, s[64:65]
  s_cbranch_scc0 L_rd_135
  s_mov_b64 exec, vcc
  buffer_load_dword v87, v63, s[40:43], 0 idxen
  s_mov_b64 exec, -1
L_rd_135:
  v_cmp_gt_u32 s[64:65], s62, v117
  v_cmp_eq_u32 vcc, 0, v93
  s_and_b64 vcc, vcc, s[64:65]
  s_cbranch_scc0 L_rd_136
  s_mov_b64 exec, vcc
  buffer_load_dword v93, v69, s[40:43], 0 idxen
  s_mov_b64 exec, -1
L_rd_136:
  s_mov_b32 s79, 0
L_px_137:
  s_mov_b64 exec, 0xffff
  buffer_load_dword v219, v218, s[40:43], 0 idxen offset:1280 sc1
  s_mov_b64 exec, -1
  s_waitcnt vmcnt(0)
  v_cmp_eq_u32 vcc, 0, v219
  s_add_u32 s79, s79, 1
  s_cbranch_vccz L_pxx_138
  s_cmp_gt_u32 s79, 0x40000
  s_cbranch_scc1 L_pxx_138
  s_sleep 16
  s_branch L_px_137
L_pxx_138:
  s_movk_i32 s62, 384
  v_cmp_gt_u32 s[64:65], s62, v98
  v_cmp_eq_u32 vcc, 0, v74
  s_and_b64 vcc, vcc, s[64:65]
  s_cbranch_scc0 L_rd_139
  s_mov_b64 exec, vcc
  buffer_load_dword v74, v50, s[40:43], 0 idxen
  s_mov_b64 exec, -1
L_rd_139:
  v_cmp_gt_u32 s[64:65], s62, v104
  v_cmp_eq_u32 vcc, 0, v80
  s_and_b64 vcc, vcc, s[64:65]
  s_cbranch_scc0 L_rd_140
  s_mov_b64 exec, vcc
  buffer_load_dword v80, v56, s[40:43], 0 idxen
  s_mov_b64 exec, -1
L_rd_140:
  v_cmp_gt_u32 s[64:65], s62, v110
  v_cmp_eq_u32 vcc, 0, v86
  s_and_b64 vcc, vcc, s[64:65]
  s_cbranch_scc0 L_rd_141
  s_mov_b64 exec, vcc
  buffer_load_dword v86, v62, s[40:43], 0 idxen
  s_mov_b64 exec, -1
L_rd_141:
  v_cmp_gt_u32 s[64:65], s62, v116
  v_cmp_eq_u32 vcc, 0, v92
  s_and_b64 vcc, vcc, s[64:65]
  s_cbranch_scc0 L_rd_142
  s_mov_b64 exec, vcc
  buffer_load_dword v92, v68, s[40:43], 0 idxen
  s_mov_b64 exec, -1
L_rd_142:
  v_cmp_gt_u32 s[64:65], s62, v99
  v_cmp_eq_u32 vcc, 0, v75
  s_and_b64 vcc, vcc, s[64:65]
  s_cbranch_scc0 L_rd_143
  s_mov_b64 exec, vcc
  buffer_load_dword v75, v51, s[40:43], 0 idxen
  s_mov_b64 exec, -1
L_rd_143:
  v_cmp_gt_u32 s[64:65], s62, v105
  v_cmp_eq_u32 vcc, 0, v81
  s_and_b64 vcc, vcc, s[64:65]
  s_cbranch_scc0 L_rd_144
  s_mov_b64 exec, vcc
  buffer_load_dword v81, v57, s[40:43], 0 idxen
  s_mov_b64 exec, -1
L_rd_144:
  v_cmp_gt_u32 s[64:65], s62, v111
  v_cmp_eq_u32 vcc, 0, v87
  s_and_b64 vcc, vcc, s[64:65]
  s_cbranch_scc0 L_rd_145
  s_mov_b64 exec, vcc
  buffer_load_dword v87, v63, s[40:43], 0 idxen
  s_mov_b64 exec, -1
L_rd_145:
  v_cmp_gt_u32 s[64:65], s62, v117
  v_cmp_eq_u32 vcc, 0, v93
  s_and_b64 vcc, vcc, s[64:65]
  s_cbranch_scc0 L_rd_146
  s_mov_b64 exec, vcc
  buffer_load_dword v93, v69, s[40:43], 0 idxen
  s_mov_b64 exec, -1
L_rd_146:
  v_cmp_gt_u32 s[64:65], s62, v100
  v_cmp_eq_u32 vcc, 0, v76
  s_and_b64 vcc, vcc, s[64:65]
  s_cbranch_scc0 L_rd_147
  s_mov_b64 exec, vcc
  buffer_load_dword v76, v52, s[40:43], 0 idxen
  s_mov_b64 exec, -1
L_rd_147:
  v_cmp_gt_u32 s[64:65], s62, v106
  v_cmp_eq_u32 vcc, 0, v82
  s_and_b64 vcc, vcc, s[64:65]
  s_cbranch_scc0 L_rd_148
  s_mov_b64 exec, vcc
  buffer_load_dword v82, v58, s[40:43], 0 idxen
  s_mov_b64 exec, -1
L_rd_148:
  v_cmp_gt_u32 s[64:65], s62, v112
  v_cmp_eq_u32 vcc, 0, v88
  s_and_b64 vcc, vcc, s[64:65]
  s_cbranch_scc0 L_rd_149
  s_mov_b64 exec, vcc
  buffer_load_dword v88, v64, s[40:43], 0 idxen
  s_mov_b64 exec, -1
L_rd_149:
  v_cmp_gt_u32 s[64:65], s62, v118
  v_cmp_eq_u32 vcc, 0, v94
  s_and_b64 vcc, vcc, s[64:65]
  s_cbranch_scc0 L_rd_150
  s_mov_b64 exec, vcc
  buffer_load_dword v94, v70, s[40:43], 0 idxen
  s_mov_b64 exec, -1
L_rd_150:
  s_mov_b32 s79, 0
L_px_151:
  s_mov_b64 exec, 0xffff
  buffer_load_dword v219, v218, s[40:43], 0 idxen offset:1536 sc1
  s_mov_b64 exec, -1
  s_waitcnt vmcnt(0)
  v_cmp_eq_u32 vcc, 0, v219
  s_add_u32 s79, s79, 1
  s_cbranch_vccz L_pxx_152
  s_cmp_gt_u32 s79, 0x40000
  s_cbranch_scc1 L_pxx_152
  s_sleep 16
  s_branch L_px_151
L_pxx_152:
  s_movk_i32 s62, 448
  v_cmp_gt_u32 s[64:65], s62, v98
  v_cmp_eq_u32 vcc, 0, v74
  s_and_b64 vcc, vcc, s[64:65]
  s_cbranch_scc0 L_rd_153
  s_mov_b64 exec, vcc
  buffer_load_dword v74, v50, s[40:43], 0 idxen
  s_mov_b64 exec, -1
L_rd_153:
  v_cmp_gt_u32 s[64:65], s62, v104
  v_cmp_eq_u32 vcc, 0, v80
  s_and_b64 vcc, vcc, s[64:65]
  s_cbranch_scc0 L_rd_154
  s_mov_b64 exec, vcc
  buffer_load_dword v80, v56, s[40:43], 0 idxen
  s_mov_b64 exec, -1
L_rd_154:
  v_cmp_gt_u32 s[64:65], s62, v110
  v_cmp_eq_u32 vcc, 0, v86
  s_and_b64 vcc, vcc, s[64:65]
  s_cbranch_scc0 L_rd_155
  s_mov_b64 exec, vcc
  buffer_load_dword v86, v62, s[40:43], 0 idxen
  s_mov_b64 exec, -1
L_rd_155:
  v_cmp_gt_u32 s[64:65], s62, v116
  v_cmp_eq_u32 vcc, 0, v92
  s_and_b64 vcc, vcc, s[64:65]
  s_cbranch_scc0 L_rd_156
  s_mov_b64 exec, vcc
  buffer_load_dword v92, v68, s[40:43], 0 idxen
  s_mov_b64 exec, -1
L_rd_156:
  v_cmp_gt_u32 s[64:65], s62, v99
  v_cmp_eq_u32 vcc, 0, v75
  s_and_b64 vcc, vcc, s[64:65]
  s_cbranch_scc0 L_rd_157
  s_mov_b64 exec, vcc
  buffer_load_dword v75, v51, s[40:43], 0 idxen
  s_mov_b64 exec, -1
L_rd_157:
  v_cmp_gt_u32 s[64:65], s62, v105
  v_cmp_eq_u32 vcc, 0, v81
  s_and_b64 vcc, vcc, s[64:65]
  s_cbranch_scc0 L_rd_158
  s_mov_b64 exec, vcc
  buffer_load_dword v81, v57, s[40:43], 0 idxen
  s_mov_b64 exec, -1
L_rd_158:
  v_cmp_gt_u32 s[64:65], s62, v111
  v_cmp_eq_u32 vcc, 0, v87
  s_and_b64 vcc, vcc, s[64:65]
  s_cbranch_scc0 L_rd_159
  s_mov_b64 exec, vcc
  buffer_load_dword v87, v63, s[40:43], 0 idxen
  s_mov_b64 exec, -1
L_rd_159:
  v_cmp_gt_u32 s[64:65], s62, v117
  v_cmp_eq_u32 vcc, 0, v93
  s_and_b64 vcc, vcc, s[64:65]
  s_cbranch_scc0 L_rd_160
  s_mov_b64 exec, vcc
  buffer_load_dword v93, v69, s[40:43], 0 idxen
  s_mov_b64 exec, -1
L_rd_160:
  v_cmp_gt_u32 s[64:65], s62, v100
  v_cmp_eq_u32 vcc, 0, v76
  s_and_b64 vcc, vcc, s[64:65]
  s_cbranch_scc0 L_rd_161
  s_mov_b64 exec, vcc
  buffer_load_dword v76, v52, s[40:43], 0 idxen
  s_mov_b64 exec, -1
L_rd_161:
  v_cmp_gt_u32 s[64:65], s62, v106
  v_cmp_eq_u32 vcc, 0, v82
  s_and_b64 vcc, vcc, s[64:65]
  s_cbranch_scc0 L_rd_162
  s_mov_b64 exec, vcc
  buffer_load_dword v82, v58, s[40:43], 0 idxen
  s_mov_b64 exec, -1
L_rd_162:
  v_cmp_gt_u32 s[64:65], s62, v112
  v_cmp_eq_u32 vcc, 0, v88
  s_and_b64 vcc, vcc, s[64:65]
  s_cbranch_scc0 L_rd_163
  s_mov_b64 exec, vcc
  buffer_load_dword v88, v64, s[40:43], 0 idxen
  s_mov_b64 exec, -1
L_rd_163:
  v_cmp_gt_u32 s[64:65], s62, v118
  v_cmp_eq_u32 vcc, 0, v94
  s_and_b64 vcc, vcc, s[64:65]
  s_cbranch_scc0 L_rd_164
  s_mov_b64 exec, vcc
  buffer_load_dword v94, v70, s[40:43], 0 idxen
  s_mov_b64 exec, -1
L_rd_164:
L_tail:
  s_setprio 3
  s_mov_b32 s79, 0
  v_subrev_u32 v218, 23, v218
  s_branch L_s7x_166
L_s7_165:
  s_mov_b64 exec, 0xffff
  buffer_load_dword v219, v218, s[40:43], 0 idxen offset:1792 sc1
  s_mov_b64 exec, -1
  s_waitcnt vmcnt(0)
  v_cmp_eq_u32 vcc, 0, v219
  s_add_u32 s79, s79, 1
  s_cbranch_vccz L_s7x_166
  s_cmp_gt_u32 s79, 0x40000
  s_cbranch_scc1 L_s7x_166
  s_sleep 2
  s_branch L_s7_165
L_s7x_166:
  s_mov_b32 s78, 0
L_retry:
  s_waitcnt vmcnt(0)
  v_min3_u32 v144, v72, v78, v84
  v_min3_u32 v145, v73, v79, v85
  v_min3_u32 v146, v74, v80, v86
  v_min3_u32 v147, v75, v81, v87
  v_min3_u32 v148, v76, v82, v88
  v_min3_u32 v149, v77, v83, v89
  v_min_u32 v144, v144, v90
  v_min_u32 v145, v145, v91
  v_min_u32 v146, v146, v92
  v_min_u32 v147, v147, v93
  v_min_u32 v148, v148, v94
  v_min_u32 v149, v149, v95
  v_min3_u32 v150, v144, v145, v146
  v_min3_u32 v151, v147, v148, v149
  v_min_u32 v150, v150, v151
  v_cmp_eq_u32 vcc, 0, v150
  s_cbranch_vccz L_soft
  s_mov_b32 s77, 1
  v_cmp_eq_u32 vcc, 0, v149
  s_cbranch_vccz L_rb_167
  v_cmp_eq_u32 vcc, 0, v77
  s_cbranch_vccz L_rt_168
  s_mov_b64 exec, vcc
  buffer_load_dword v77, v53, s[40:43], 0 idxen sc1
  s_mov_b64 exec, -1
L_rt_168:
  v_cmp_eq_u32 vcc, 0, v83
  s_cbranch_vccz L_rt_169
  s_mov_b64 exec, vcc
  buffer_load_dword v83, v59, s[40:43], 0 idxen sc1
  s_mov_b64 exec, -1
L_rt_169:
  v_cmp_eq_u32 vcc, 0, v89
  s_cbranch_vccz L_rt_170
  s_mov_b64 exec, vcc
  buffer_load_dword v89, v65, s[40:43], 0 idxen sc1
  s_mov_b64 exec, -1
L_rt_170:
  v_cmp_eq_u32 vcc, 0, v95
  s_cbranch_vccz L_rt_171
  s_mov_b64 exec, vcc
  buffer_load_dword v95, v71, s[40:43], 0 idxen sc1
  s_mov_b64 exec, -1
L_rt_171:
L_rb_167:
  v_cmp_eq_u32 vcc, 0, v148
  s_cbranch_vccz L_rb_172
  v_cmp_eq_u32 vcc, 0, v76
  s_cbranch_vccz L_rt_173
  s_mov_b64 exec, vcc
  buffer_load_dword v76, v52, s[40:43], 0 idxen sc1
  s_mov_b64 exec, -1
L_rt_173:
  v_cmp_eq_u32 vcc, 0, v82
  s_cbranch_vccz L_rt_174
  s_mov_b64 exec, vcc
  buffer_load_dword v82, v58, s[40:43], 0 idxen sc1
  s_mov_b64 exec, -1
L_rt_174:
  v_cmp_eq_u32 vcc, 0, v88
  s_cbranch_vccz L_rt_175
  s_mov_b64 exec, vcc
  buffer_load_dword v88, v64, s[40:43], 0 idxen sc1
  s_mov_b64 exec, -1
L_rt_175:
  v_cmp_eq_u32 vcc, 0, v94
  s_cbranch_vccz L_rt_176
  s_mov_b64 exec, vcc
  buffer_load_dword v94, v70, s[40:43], 0 idxen sc1
  s_mov_b64 exec, -1
L_rt_176:
L_rb_172:
  v_cmp_eq_u32 vcc, 0, v147
  s_cbranch_vccz L_rb_177
  v_cmp_eq_u32 vcc, 0, v75
  s_cbranch_vccz L_rt_178
  s_mov_b64 exec, vcc
  buffer_load_dword v75, v51, s[40:43], 0 idxen sc1
  s_mov_b64 exec, -1
L_rt_178:
  v_cmp_eq_u32 vcc, 0, v81
  s_cbranch_vccz L_rt_179
  s_mov_b64 exec, vcc
  buffer_load_dword v81, v57, s[40:43], 0 idxen sc1
  s_mov_b64 exec, -1
L_rt_179:
  v_cmp_eq_u32 vcc, 0, v87
  s_cbranch_vccz L_rt_180
  s_mov_b64 exec, vcc
  buffer_load_dword v87, v63, s[40:43], 0 idxen sc1
  s_mov_b64 exec, -1
L_rt_180:
  v_cmp_eq_u32 vcc, 0, v93
  s_cbranch_vccz L_rt_181
  s_mov_b64 exec, vcc
  buffer_load_dword v93, v69, s[40:43], 0 idxen sc1
  s_mov_b64 exec, -1
L_rt_181:
L_rb_177:
  v_cmp_eq_u32 vcc, 0, v146
  s_cbranch_vccz L_rb_182
  v_cmp_eq_u32 vcc, 0, v74
  s_cbranch_vccz L_rt_183
  s_mov_b64 exec, vcc
  buffer_load_dword v74, v50, s[40:43], 0 idxen sc1
  s_mov_b64 exec, -1
L_rt_183:
  v_cmp_eq_u32 vcc, 0, v80
  s_cbranch_vccz L_rt_184
  s_mov_b64 exec, vcc
  buffer_load_dword v80, v56, s[40:43], 0 idxen sc1
  s_mov_b64 exec, -1
L_rt_184:
  v_cmp_eq_u32 vcc, 0, v86
  s_cbranch_vccz L_rt_185
  s_mov_b64 exec, vcc
  buffer_load_dword v86, v62, s[40:43], 0 idxen sc1
  s_mov_b64 exec, -1
L_rt_185:
  v_cmp_eq_u32 vcc, 0, v92
  s_cbranch_vccz L_rt_186
  s_mov_b64 exec, vcc
  buffer_load_dword v92, v68, s[40:43], 0 idxen sc1
  s_mov_b64 exec, -1
L_rt_186:
L_rb_182:
  v_cmp_eq_u32 vcc, 0, v145
  s_cbranch_vccz L_rb_187
  v_cmp_eq_u32 vcc, 0, v73
  s_cbranch_vccz L_rt_188
  s_mov_b64 exec, vcc
  buffer_load_dword v73, v49, s[40:43], 0 idxen sc1
  s_mov_b64 exec, -1
L_rt_188:
  v_cmp_eq_u32 vcc, 0, v79
  s_cbranch_vccz L_rt_189
  s_mov_b64 exec, vcc
  buffer_load_dword v79, v55, s[40:43], 0 idxen sc1
  s_mov_b64 exec, -1
L_rt_189:
  v_cmp_eq_u32 vcc, 0, v85
  s_cbranch_vccz L_rt_190
  s_mov_b64 exec, vcc
  buffer_load_dword v85, v61, s[40:43], 0 idxen sc1
  s_mov_b64 exec, -1
L_rt_190:
  v_cmp_eq_u32 vcc, 0, v91
  s_cbranch_vccz L_rt_191
  s_mov_b64 exec, vcc
  buffer_load_dword v91, v67, s[40:43], 0 idxen sc1
  s_mov_b64 exec, -1
L_rt_191:
L_rb_187:
  v_cmp_eq_u32 vcc, 0, v144
  s_cbranch_vccz L_rb_192
  v_cmp_eq_u32 vcc, 0, v72
  s_cbranch_vccz L_rt_193
  s_mov_b64 exec, vcc
  buffer_load_dword v72, v48, s[40:43], 0 idxen sc1
  s_mov_b64 exec, -1
L_rt_193:
  v_cmp_eq_u32 vcc, 0, v78
  s_cbranch_vccz L_rt_194
  s_mov_b64 exec, vcc
  buffer_load_dword v78, v54, s[40:43], 0 idxen sc1
  s_mov_b64 exec, -1
L_rt_194:
  v_cmp_eq_u32 vcc, 0, v84
  s_cbranch_vccz L_rt_195
  s_mov_b64 exec, vcc
  buffer_load_dword v84, v60, s[40:43], 0 idxen sc1
  s_mov_b64 exec, -1
L_rt_195:
  v_cmp_eq_u32 vcc, 0, v90
  s_cbranch_vccz L_rt_196
  s_mov_b64 exec, vcc
  buffer_load_dword v90, v66, s[40:43], 0 idxen sc1
  s_mov_b64 exec, -1
L_rt_196:
L_rb_192:
  s_add_u32 s78, s78, 1
  s_cmp_eq_u32 s77, 0
  s_cbranch_scc1 L_soft
  s_cmp_lt_u32 s78, 0x40000
  s_cbranch_scc1 L_retry
L_soft:
  v_lshlrev_b32 v96, 16, v72
  v_and_b32 v120, 0xffff0000, v72
  v_lshlrev_b32 v97, 16, v73
  v_and_b32 v121, 0xffff0000, v73
  v_lshlrev_b32 v98, 16, v74
  v_and_b32 v122, 0xffff0000, v74
  v_lshlrev_b32 v99, 16, v75
  v_and_b32 v123, 0xffff0000, v75
  v_lshlrev_b32 v100, 16, v76
  v_and_b32 v124, 0xffff0000, v76
  v_lshlrev_b32 v101, 16, v77
  v_and_b32 v125, 0xffff0000, v77
  v_lshlrev_b32 v102, 16, v78
  v_and_b32 v126, 0xffff0000, v78
  v_lshlrev_b32 v103, 16, v79
  v_and_b32 v127, 0xffff0000, v79
  v_lshlrev_b32 v104, 16, v80
  v_and_b32 v128, 0xffff0000, v80
  v_lshlrev_b32 v105, 16, v81
  v_and_b32 v129, 0xffff0000, v81
  v_lshlrev_b32 v106, 16, v82
  v_and_b32 v130, 0xffff0000, v82
  v_lshlrev_b32 v107, 16, v83
  v_and_b32 v131, 0xffff0000, v83
  v_lshlrev_b32 v108, 16, v84
  v_and_b32 v132, 0xffff0000, v84
  v_lshlrev_b32 v109, 16, v85
  v_and_b32 v133, 0xffff0000, v85
  v_lshlrev_b32 v110, 16, v86
  v_and_b32 v134, 0xffff0000, v86
  v_lshlrev_b32 v111, 16, v87
  v_and_b32 v135, 0xffff0000, v87
  v_lshlrev_b32 v112, 16, v88
  v_and_b32 v136, 0xffff0000, v88
  v_lshlrev_b32 v113, 16, v89
  v_and_b32 v137, 0xffff0000, v89
  v_lshlrev_b32 v114, 16, v90
  v_and_b32 v138, 0xffff0000, v90
  v_lshlrev_b32 v115, 16, v91
  v_and_b32 v139, 0xffff0000, v91
  v_lshlrev_b32 v116, 16, v92
  v_and_b32 v140, 0xffff0000, v92
  v_lshlrev_b32 v117, 16, v93
  v_and_b32 v141, 0xffff0000, v93
  v_lshlrev_b32 v118, 16, v94
  v_and_b32 v142, 0xffff0000, v94
  v_lshlrev_b32 v119, 16, v95
  v_and_b32 v143, 0xffff0000, v95
  v_max3_f32 v144, v96, v97, v98
  v_max3_f32 v144, v144, v99, v100
  v_max_f32 v144, v144, v101
  v_max3_f32 v145, v102, v103, v104
  v_max3_f32 v145, v145, v105, v106
  v_max_f32 v145, v145, v107
  v_max3_f32 v146, v108, v109, v110
  v_max3_f32 v146, v146, v111, v112
  v_max_f32 v146, v146, v113
  v_max3_f32 v147, v114, v115, v116
  v_max3_f32 v147, v147, v117, v118
  v_max_f32 v147, v147, v119
  s_nop 1
  v_permlane32_swap_b32 v144, v146
  v_permlane32_swap_b32 v145, v147
  s_nop 0
  v_max_f32 v144, v144, v146
  v_max_f32 v145, v145, v147
  s_nop 1
  v_permlane16_swap_b32 v144, v145
  s_nop 0
  v_max_f32 v160, v144, v145
  s_nop 1
  v_max_f32_dpp v160, v160, v160 row_ror:8 row_mask:0xf bank_mask:0xf
  s_nop 1
  v_max_f32_dpp v160, v160, v160 row_ror:4 row_mask:0xf bank_mask:0xf
  s_nop 1
  v_max_f32_dpp v160, v160, v160 row_ror:2 row_mask:0xf bank_mask:0xf
  s_nop 1
  v_max_f32_dpp v160, v160, v160 row_ror:1 row_mask:0xf bank_mask:0xf
  s_nop 1
  v_readlane_b32 s70, v160, 0
  v_readlane_b32 s71, v160, 16
  v_readlane_b32 s72, v160, 32
  v_readlane_b32 s73, v160, 48
  s_nop 1
  v_subrev_f32 v96, s70, v96
  v_subrev_f32 v97, s70, v97
  v_subrev_f32 v98, s70, v98
  v_subrev_f32 v99, s70, v99
  v_subrev_f32 v100, s70, v100
  v_subrev_f32 v101, s70, v101
  v_subrev_f32 v102, s71, v102
  v_subrev_f32 v103, s71, v103
  v_subrev_f32 v104, s71, v104
  v_subrev_f32 v105, s71, v105
  v_subrev_f32 v106, s71, v106
  v_subrev_f32 v107, s71, v107
  v_subrev_f32 v108, s72, v108
  v_subrev_f32 v109, s72, v109
  v_subrev_f32 v110, s72, v110
  v_subrev_f32 v111, s72, v111
  v_subrev_f32 v112, s72, v112
  v_subrev_f32 v113, s72, v113
  v_subrev_f32 v114, s73, v114
  v_subrev_f32 v115, s73, v115
  v_subrev_f32 v116, s73, v116
  v_subrev_f32 v117, s73, v117
  v_subrev_f32 v118, s73, v118
  v_subrev_f32 v119, s73, v119
  v_exp_f32 v96, v96
  v_exp_f32 v97, v97
  v_exp_f32 v98, v98
  v_exp_f32 v99, v99
  v_exp_f32 v100, v100
  v_exp_f32 v101, v101
  v_exp_f32 v102, v102
  v_exp_f32 v103, v103
  v_exp_f32 v104, v104
  v_exp_f32 v105, v105
  v_exp_f32 v106, v106
  v_exp_f32 v107, v107
  v_exp_f32 v108, v108
  v_exp_f32 v109, v109
  v_exp_f32 v110, v110
  v_exp_f32 v111, v111
  v_exp_f32 v112, v112
  v_exp_f32 v113, v113
  v_exp_f32 v114, v114
  v_exp_f32 v115, v115
  v_exp_f32 v116, v116
  v_exp_f32 v117, v117
  v_exp_f32 v118, v118
  v_exp_f32 v119, v119
  v_add_f32 v148, v96, v97
  v_mul_f32 v152, v96, v120
  v_add_f32 v149, v102, v103
  v_mul_f32 v153, v102, v126
  v_add_f32 v150, v108, v109
  v_mul_f32 v154, v108, v132
  v_add_f32 v151, v114, v115
  v_mul_f32 v155, v114, v138
  v_fma_f32 v152, v97, v121, v152
  v_fma_f32 v153, v103, v127, v153
  v_fma_f32 v154, v109, v133, v154
  v_fma_f32 v155, v115, v139, v155
  v_add_f32 v148, v148, v98
  v_fma_f32 v152, v98, v122, v152
  v_add_f32 v149, v149, v104
  v_fma_f32 v153, v104, v128, v153
  v_add_f32 v150, v150, v110
  v_fma_f32 v154, v110, v134, v154
  v_add_f32 v151, v151, v116
  v_fma_f32 v155, v116, v140, v155
  v_add_f32 v148, v148, v99
  v_fma_f32 v152, v99, v123, v152
  v_add_f32 v149, v149, v105
  v_fma_f32 v153, v105, v129, v153
  v_add_f32 v150, v150, v111
  v_fma_f32 v154, v111, v135, v154
  v_add_f32 v151, v151, v117
  v_fma_f32 v155, v117, v141, v155
  v_add_f32 v148, v148, v100
  v_fma_f32 v152, v100, v124, v152
  v_add_f32 v149, v149, v106
  v_fma_f32 v153, v106, v130, v153
  v_add_f32 v150, v150, v112
  v_fma_f32 v154, v112, v136, v154
  v_add_f32 v151, v151, v118
  v_fma_f32 v155, v118, v142, v155
  v_add_f32 v148, v148, v101
  v_fma_f32 v152, v101, v125, v152
  v_add_f32 v149, v149, v107
  v_fma_f32 v153, v107, v131, v153
  v_add_f32 v150, v150, v113
  v_fma_f32 v154, v113, v137, v154
  v_add_f32 v151, v151, v119
  v_fma_f32 v155, v119, v143, v155
  s_nop 1
  v_permlane32_swap_b32 v148, v150
  v_permlane32_swap_b32 v149, v151
  v_permlane32_swap_b32 v152, v154
  v_permlane32_swap_b32 v153, v155
  v_add_f32 v148, v148, v150
  v_add_f32 v149, v149, v151
  v_add_f32 v152, v152, v154
  v_add_f32 v153, v153, v155
  s_nop 0
  v_permlane16_swap_b32 v148, v149
  v_permlane16_swap_b32 v152, v153
  s_nop 0
  v_add_f32 v160, v148, v149
  v_add_f32 v161, v152, v153
  s_nop 0
  v_add_f32_dpp v160, v160, v160 row_ror:8 row_mask:0xf bank_mask:0xf
  v_add_f32_dpp v161, v161, v161 row_ror:8 row_mask:0xf bank_mask:0xf
  s_nop 0
  v_add_f32_dpp v160, v160, v160 row_ror:4 row_mask:0xf bank_mask:0xf
  v_add_f32_dpp v161, v161, v161 row_ror:4 row_mask:0xf bank_mask:0xf
  s_nop 0
  v_add_f32_dpp v160, v160, v160 row_ror:2 row_mask:0xf bank_mask:0xf
  v_add_f32_dpp v161, v161, v161 row_ror:2 row_mask:0xf bank_mask:0xf
  s_nop 0
  v_add_f32_dpp v160, v160, v160 row_ror:1 row_mask:0xf bank_mask:0xf
  v_add_f32_dpp v161, v161, v161 row_ror:1 row_mask:0xf bank_mask:0xf
  v_lshrrev_b32 v162, 3, v223
  v_rcp_f32 v160, v160
  s_lshl_b32 s59, s2, 5
  s_lshl_b32 s60, s26, 3
  s_add_u32 s59, s59, s60
  v_mul_f32 v161, v161, v160
  s_mov_b32 exec_lo, 0x00010001
  s_mov_b32 exec_hi, 0x00010001
  v_cvt_pk_bf16_f32 v161, v161, v161
  buffer_store_short v161, v162, s[48:51], s59 offen
  s_endpgm
L_end:
  s_endpgm
.section .rodata,"a"
.p2align 6
.amdhsa_kernel standalone__factorization_afm__recsys_kernel
  .amdhsa_next_free_vgpr 256
  .amdhsa_next_free_sgpr 102
  .amdhsa_accum_offset 224
  .amdhsa_group_segment_fixed_size 0
  .amdhsa_kernarg_size 88
  .amdhsa_user_sgpr_count 2
  .amdhsa_user_sgpr_kernarg_segment_ptr 1
  .amdhsa_system_sgpr_workgroup_id_x 1
.end_amdhsa_kernel
```
